```python
import torch

def _softmax(x, axis=-1):
    return torch.softmax(x, dim=axis)
def _gelu(x):
    return torch.nn.functional.gelu(x, approximate="tanh")
def _silu(x):
    return torch.nn.functional.silu(x)
def _sigmoid(x):
    return torch.sigmoid(x)
def _layernorm(x, axis=-1, eps=1e-5):
    m = x.mean(dim=axis, keepdim=True)
    v = x.var(dim=axis, keepdim=True, unbiased=False)
    return (x - m) / torch.sqrt(v + eps)
def _scatter_add(tgt, idx, src, axis=0):
    return tgt.clone().index_add_(axis, idx, src)
def _segment_sum(src, seg, n):
    out = torch.zeros((n,) + src.shape[1:], dtype=src.dtype)
    return out.index_add_(0, seg, src)
def _pad(x, pw):
    flat = tuple(v for pair in reversed(pw) for v in pair)
    return torch.nn.functional.pad(x, flat)

kernel_name = 'concat_heads__ssm_conv_s4d__linear_attn_block__prompt'

def setup_inputs():

    _w = (lambda a: (lambda t: t.to(torch.bfloat16) if t.is_floating_point() else t)(torch.as_tensor(a)))
    def _A_setup():
        Bsz, L, D, N = 1, 2048, 640, 128
        return {
            "u": _w((lambda *s: torch.randn(*s, dtype=torch.bfloat16) * 0.05)(Bsz, L, D)),
            "log_A_real": _w((lambda *s: torch.randn(*s, dtype=torch.bfloat16) * 3.2)(D, N) * 0.5),
            "A_imag": _w((lambda *s: torch.randn(*s, dtype=torch.bfloat16) * 0.05)(D, N) * 3.14),
            "C_real": _w((lambda *s: torch.randn(*s, dtype=torch.bfloat16) * 0.2)(D, N) / N ** 0.5),
            "C_imag": _w((lambda *s: torch.randn(*s, dtype=torch.bfloat16) * 0.2)(D, N) / N ** 0.5),
            "log_dt": _w((lambda *s: torch.randn(*s, dtype=torch.bfloat16) * 0.05)(D) * 0.5 - 4.0),
            "D_skip": _w((lambda *s: torch.randn(*s, dtype=torch.bfloat16) * 0.05)(D)),
        }
    _A_in = _A_setup()

    def _B_setup():
        B, S, D = 1, 2048, 640
        return {
            "x": _w((lambda *s: torch.randn(*s, dtype=torch.bfloat16) * 0.05)(B, S, D)),
            "wqkv": _w((lambda *s: torch.randn(*s, dtype=torch.bfloat16) * 0.4)(D, 3 * D)),
            "wo": _w((lambda *s: torch.randn(*s, dtype=torch.bfloat16) * 0.05)(D, D)),
        }
    _B_in = _B_setup()

    return {
        "A_u": _A_in["u"],
        "A_log_A_real": _A_in["log_A_real"],
        "A_A_imag": _A_in["A_imag"],
        "A_C_real": _A_in["C_real"],
        "A_C_imag": _A_in["C_imag"],
        "A_log_dt": _A_in["log_dt"],
        "A_D_skip": _A_in["D_skip"],
        "B_x": _B_in["x"],
        "B_wqkv": _B_in["wqkv"],
        "B_wo": _B_in["wo"],
    }

def reference(A_u, A_log_A_real, A_A_imag, A_C_real, A_C_imag, A_log_dt, A_D_skip, B_x, B_wqkv, B_wo):
    def _A_ref(u, log_A_real, A_imag, C_real, C_imag, log_dt, D_skip):
        L = u.shape[1]
        dt = torch.exp(log_dt)
        A = -torch.exp(log_A_real) + 1j * A_imag
        C = (C_real + 1j * C_imag) * dt[:, None]
        pos = (lambda x, dt: x.to(dt))(torch.arange(L), log_dt.dtype)
        P = torch.exp((A * dt[:, None])[:, :, None] * pos[None, None, :])
        K = 2.0 * torch.einsum("dn,dnl->dl", C, P).real
        L2 = 2 * L
        u_t = (lambda x, *d: x.permute(*d))(u, 0, 2, 1)
        Kf = (lambda x, *a, **k: torch.fft.rfft(x.float(), *a, **k))(K, L2)
        Uf = (lambda x, *a, **k: torch.fft.rfft(x.float(), *a, **k))(u_t, L2)
        y = (lambda x, *a, **k: torch.fft.irfft(x, *a, **k).to(torch.bfloat16))(Uf * Kf[None, :, :], L2)[:, :, :L]
        y = (lambda x, *d: x.permute(*d))(y, 0, 2, 1)
        return y + u * D_skip[None, None, :]

    def _B_ref(x, wqkv, wo):
        B, S, D = x.shape
        H = 32; Dh = D // H
        qkv = (lambda x, *d: x.permute(*d))((x @ wqkv).reshape(B, S, 3, H, Dh), 2, 0, 3, 1, 4)
        q, k, v = qkv[0], qkv[1], qkv[2]
        phi = lambda t: torch.where(t > 0, t + 1, torch.exp(t)) + 1e-6
        pq, pk = phi(q), phi(k)
        kv = torch.einsum("bhsd,bhse->bhde", pk, v)
        z = torch.einsum("bhsd->bhd", pk)
        num = torch.einsum("bhqd,bhde->bhqe", pq, kv)
        den = torch.einsum("bhqd,bhd->bhq", pq, z)[..., None] + 1e-6
        o = num / den
        return (lambda x, *d: x.permute(*d))(o, 0, 2, 1, 3).reshape(B, S, D) @ wo

    a = _A_ref(A_u, A_log_A_real, A_A_imag, A_C_real, A_C_imag, A_log_dt, A_D_skip)
    b = _B_ref(B_x, B_wqkv, B_wo)
    return torch.concatenate([a, b], axis=-1)
```

```asm
; @launch grid=(256,1,1) block=(512,1,1) lds=163840
.amdgcn_target "amdgcn-amd-amdhsa--gfx950"
.text
.globl concat_heads__ssm_conv_s4d__linear_attn_block__prompt_kernel
.p2align 8
.type concat_heads__ssm_conv_s4d__linear_attn_block__prompt_kernel,@function
concat_heads__ssm_conv_s4d__linear_attn_block__prompt_kernel:
 s_getpc_b64 s[32:33]
 s_cmp_ge_u32 s2, 256
 s_cbranch_scc1 L_end
 s_cmp_lt_u32 s2, 224
 s_cbranch_scc1 L_e0
 v_lshlrev_b32 v1, 7, v0
 v_min_u32 v1, L_tab - concat_heads__ssm_conv_s4d__linear_attn_block__prompt_kernel + 4032, v1
 global_load_dword v2, v1, s[32:33]
L_e0:
 s_load_dwordx16 s[36:51], s[0:1], 0
 s_load_dwordx8 s[52:59], s[0:1], 64
 s_load_dwordx2 s[30:31], s[0:1], 96
 v_lshrrev_b32 v1, 6, v0
 s_and_b32 s24, s2, 7
 v_readfirstlane_b32 s20, v1
 s_lshr_b32 s25, s2, 3
 s_cmp_ge_u32 s25, 16
 s_cbranch_scc1 L_roleA

 s_cmp_ge_u32 s20, 4
 s_cbranch_scc1 LB_lstart
 s_cmp_eq_u32 s20, 3
 s_cbranch_scc1 LB_compute
 s_cmp_lg_u32 s20, 0
 s_cbranch_scc1 LB_cpw
 v_and_b32 v2, 31, v0
 v_mul_u32_u24 v2, 1280, v2
 v_lshlrev_b32 v3, 2, v0
 v_and_b32 v3, 128, v3
 s_lshr_b32 s60, s24, 1
 s_lshl_b32 s60, s60, 4
 s_add_u32 s60, s60, s25
 s_mul_i32 s60, s60, 40960
 v_add3_u32 v2, v2, v3, s60
 s_waitcnt lgkmcnt(0)
 global_load_dword v255, v2, s[50:51]
 s_branch LB_compute
LB_cpw:
 v_and_b32 v2, 7, v0
 v_mul_u32_u24 v2, 3840, v2
 v_bfe_u32 v3, v0, 3, 3
 v_min_u32 v3, 4, v3
 v_lshlrev_b32 v3, 7, v3
 s_mul_i32 s60, s25, 30720
 s_mul_i32 s61, s20, 1280
 s_add_u32 s60, s60, s61
 s_and_b32 s61, s24, 1
 s_mul_i32 s61, s61, 640
 s_add_u32 s60, s60, s61
 v_add3_u32 v2, v2, v3, s60
 s_waitcnt lgkmcnt(0)
 global_load_dword v255, v2, s[52:53]
 s_branch LB_compute
LB_lstart:
 s_add_u32 s28, s32, L_tab - concat_heads__ssm_conv_s4d__linear_attn_block__prompt_kernel - 4
 s_addc_u32 s29, s33, 0
 v_and_b32 v1, 127, v0
 v_lshlrev_b32 v1, 5, v1
 global_load_dwordx4 v[2:5], v1, s[28:29]
 global_load_dwordx4 v[6:9], v1, s[28:29] offset:16
 s_lshr_b32 s22, s24, 1
 s_lshl_b32 s22, s22, 2
 s_lshr_b32 s26, s25, 2
 s_add_u32 s22, s22, s26
 s_and_b32 s23, s24, 1
 s_mul_i32 s27, s23, 5
 s_lshl_b32 s23, s23, 2
 s_and_b32 s28, s25, 3
 s_add_u32 s27, s27, s28
 s_add_u32 s23, s23, s28
 v_and_b32 v1, 63, v0
 s_and_b32 s8, s20, 3

 s_mul_i32 s9, s22, 163840
 s_mul_i32 s61, s8, 40960
 s_add_u32 s9, s9, s61
 s_lshl_b32 s12, s8, 12
 s_mul_i32 s13, s8, 5120
 s_lshr_b32 s62, s8, 1
 s_mul_i32 s10, s23, 160
 s_mul_i32 s16, s62, 245760
 s_add_u32 s16, s16, s10
 s_mul_i32 s62, s62, 1280
 s_add_u32 s10, s10, s62
 s_add_u32 s10, s10, 1280

 s_and_b32 s64, s22, 3
 s_mul_i32 s64, s64, 0x8080000
 s_movk_i32 s65, 3840
 s_and_b32 s61, s23, 3
 s_mul_i32 s66, s61, 10240
 s_xor_b32 s67, s61, 1
 s_mul_i32 s67, s67, 10240
 s_sub_u32 s67, s67, 1024
 s_xor_b32 s62, s61, 2
 s_mul_i32 s62, s62, 10240
 s_sub_u32 s62, s62, 2048
 s_xor_b32 s63, s61, 3
 s_mul_i32 s63, s63, 10240
 s_sub_u32 s63, s63, 3072
 s_waitcnt lgkmcnt(0)
 s_sub_u32 s68, s50, 4096
 s_subb_u32 s69, s51, 0
 s_mov_b32 s70, 2625536
 s_mov_b32 s71, 0x20000
 s_sub_u32 s72, s52, 4096
 s_subb_u32 s73, s53, 0
 s_mov_b32 s74, 2461696
 s_mov_b32 s75, 0x20000
 s_waitcnt vmcnt(0)
 v_xor_b32 v40, s64, v2
 v_xor_b32 v41, s64, v3
 v_xor_b32 v42, s64, v4
 v_xor_b32 v43, s64, v5
 v_xor_b32 v44, s64, v6
 v_bfe_u32 v12, v40, 16, 6
 v_and_b32 v2, 0xffff, v40
 v_bfe_u32 v13, v41, 16, 6
 v_and_b32 v3, 0xffff, v41
 v_bfe_u32 v14, v42, 16, 6
 v_and_b32 v4, 0xffff, v42
 v_bfe_u32 v15, v43, 16, 6
 v_and_b32 v5, 0xffff, v43
 v_bfe_u32 v16, v44, 16, 6
 v_and_b32 v6, 0xffff, v44
 v_mad_u32_u24 v2, v12, s65, v2
 v_mad_u32_u24 v3, v13, s65, v3
 v_mad_u32_u24 v4, v14, s65, v4
 v_mad_u32_u24 v5, v15, s65, v5
 v_mad_u32_u24 v6, v16, s65, v6
 s_add_u32 m0, s13, 65536
 s_add_u32 s60, s10, 245760
 buffer_load_dwordx4 v2, s[72:75], s10 offen offset:0 lds
 buffer_load_dwordx4 v3, s[72:75], s10 offen offset:1024 lds
 buffer_load_dwordx4 v4, s[72:75], s10 offen offset:2048 lds
 buffer_load_dwordx4 v5, s[72:75], s10 offen offset:3072 lds
 s_add_u32 m0, m0, 4096
 s_cmp_ge_u32 s60, 2457600
 buffer_load_dwordx4 v6, s[72:75], s10 offen lds
 s_mov_b32 s10, s60
 v_add_u32 v10, s62, v8
 v_add_u32 v11, s63, v9
 v_add_u32 v8, s66, v8
 v_add_u32 v9, s67, v9
 s_add_u32 m0, s12, 0
 s_add_u32 s60, s9, 128
 buffer_load_dwordx4 v8, s[68:71], s9 offen offset:0 lds
 buffer_load_dwordx4 v9, s[68:71], s9 offen offset:1024 lds
 buffer_load_dwordx4 v10, s[68:71], s9 offen offset:2048 lds
 buffer_load_dwordx4 v11, s[68:71], s9 offen offset:3072 lds
 s_mov_b32 s9, s60
 s_add_u32 m0, s12, 16384
 s_add_u32 s60, s9, 128
 buffer_load_dwordx4 v8, s[68:71], s9 offen offset:0 lds
 buffer_load_dwordx4 v9, s[68:71], s9 offen offset:1024 lds
 buffer_load_dwordx4 v10, s[68:71], s9 offen offset:2048 lds
 buffer_load_dwordx4 v11, s[68:71], s9 offen offset:3072 lds
 s_mov_b32 s9, s60
 s_add_u32 m0, s13, 86016
 s_add_u32 s60, s10, 245760
 buffer_load_dwordx4 v2, s[72:75], s10 offen offset:0 lds
 buffer_load_dwordx4 v3, s[72:75], s10 offen offset:1024 lds
 buffer_load_dwordx4 v4, s[72:75], s10 offen offset:2048 lds
 buffer_load_dwordx4 v5, s[72:75], s10 offen offset:3072 lds
 s_add_u32 m0, m0, 4096
 s_cmp_ge_u32 s60, 2457600
 buffer_load_dwordx4 v6, s[72:75], s10 offen lds
 s_mov_b32 s10, s60
 s_waitcnt vmcnt(9) lgkmcnt(0)
 s_barrier
 s_add_u32 m0, s12, 32768
 s_add_u32 s60, s9, 128
 buffer_load_dwordx4 v8, s[68:71], s9 offen offset:0 lds
 buffer_load_dwordx4 v9, s[68:71], s9 offen offset:1024 lds
 buffer_load_dwordx4 v10, s[68:71], s9 offen offset:2048 lds
 buffer_load_dwordx4 v11, s[68:71], s9 offen offset:3072 lds
 s_mov_b32 s9, s60
 v_and_b32 v20, 31, v1
 s_and_b32 s60, s23, 3
 s_lshl_b32 s60, s60, 3
 v_xor_b32 v20, s60, v20
 v_lshrrev_b32 v21, 5, v1
 v_bfe_u32 v16, v20, 1, 3
 v_xor_b32 v16, v16, v21
 s_and_b32 s60, s22, 3
 v_xor_b32 v16, s60, v16
 v_lshlrev_b32 v20, 7, v20
 v_lshl_add_u32 v12, v16, 4, v20
 s_lshl_b32 s60, s8, 12
 v_add_u32 v12, s60, v12
 v_xor_b32 v13, 32, v12
 v_xor_b32 v14, 64, v12
 v_xor_b32 v15, 0x60, v12
 v_bfe_u32 v20, v1, 2, 2
 v_lshl_add_u32 v20, v21, 2, v20
 v_mul_u32_u24 v20, 320, v20
 v_and_b32 v21, 3, v1
 v_lshl_add_u32 v20, v21, 3, v20
 v_bfe_u32 v21, v1, 4, 1
 v_lshl_add_u32 v16, v21, 5, v20
 v_add_u32 v17, 0x10000, v16
 v_add_u32 v18, 0x20000, v16
 ds_read_b128 v[96:99], v12 offset:0
 ds_read_b128 v[100:103], v13 offset:0
 ds_read_b128 v[104:107], v14 offset:0
 ds_read_b128 v[108:111], v15 offset:0
 s_add_u32 m0, s13, 106496
 s_add_u32 s60, s10, 245760
 buffer_load_dwordx4 v2, s[72:75], s10 offen offset:0 lds
 buffer_load_dwordx4 v3, s[72:75], s10 offen offset:1024 lds
 buffer_load_dwordx4 v4, s[72:75], s10 offen offset:2048 lds
 buffer_load_dwordx4 v5, s[72:75], s10 offen offset:3072 lds
 s_add_u32 m0, m0, 4096
 s_cmp_ge_u32 s60, 2457600
 buffer_load_dwordx4 v6, s[72:75], s10 offen lds
 s_mov_b32 s10, s60
 s_waitcnt vmcnt(9) lgkmcnt(0)
 s_barrier
 s_add_u32 m0, s12, 49152
 s_add_u32 s60, s9, 128
 buffer_load_dwordx4 v8, s[68:71], s9 offen offset:0 lds
 buffer_load_dwordx4 v9, s[68:71], s9 offen offset:1024 lds
 buffer_load_dwordx4 v10, s[68:71], s9 offen offset:2048 lds
 buffer_load_dwordx4 v11, s[68:71], s9 offen offset:3072 lds
 s_mov_b32 s9, s60
 s_add_u32 m0, s13, 126976
 s_add_u32 s60, s10, 245760
 buffer_load_dwordx4 v2, s[72:75], s10 offen offset:0 lds
 buffer_load_dwordx4 v3, s[72:75], s10 offen offset:1024 lds
 buffer_load_dwordx4 v4, s[72:75], s10 offen offset:2048 lds
 buffer_load_dwordx4 v5, s[72:75], s10 offen offset:3072 lds
 s_add_u32 m0, m0, 4096
 s_cmp_ge_u32 s60, 2457600
 buffer_load_dwordx4 v6, s[72:75], s10 offen lds
 s_mov_b32 s10, s60
 s_add_u32 m0, s12, 0
 s_add_u32 s60, s9, 128
 buffer_load_dwordx4 v8, s[68:71], s9 offen offset:0 lds
 buffer_load_dwordx4 v9, s[68:71], s9 offen offset:1024 lds
 buffer_load_dwordx4 v10, s[68:71], s9 offen offset:2048 lds
 buffer_load_dwordx4 v11, s[68:71], s9 offen offset:3072 lds
 s_mov_b32 s9, s60
 ds_read_b128 v[112:115], v12 offset:16384
 ds_read_b128 v[116:119], v13 offset:16384
 ds_read_b128 v[120:123], v14 offset:16384
 ds_read_b128 v[124:127], v15 offset:16384
 s_waitcnt vmcnt(13) lgkmcnt(0)
 s_barrier
 s_add_u32 m0, s13, 65536
 s_add_u32 s60, s10, 245760
 buffer_load_dwordx4 v2, s[72:75], s10 offen offset:0 lds
 buffer_load_dwordx4 v3, s[72:75], s10 offen offset:1024 lds
 buffer_load_dwordx4 v4, s[72:75], s10 offen offset:2048 lds
 buffer_load_dwordx4 v5, s[72:75], s10 offen offset:3072 lds
 s_add_u32 m0, m0, 4096
 s_cmp_ge_u32 s60, 2457600
 buffer_load_dwordx4 v6, s[72:75], s10 offen lds
 s_mov_b32 s10, s60
 s_add_u32 m0, s12, 16384
 s_add_u32 s60, s9, 128
 buffer_load_dwordx4 v8, s[68:71], s9 offen offset:0 lds
 buffer_load_dwordx4 v9, s[68:71], s9 offen offset:1024 lds
 buffer_load_dwordx4 v10, s[68:71], s9 offen offset:2048 lds
 buffer_load_dwordx4 v11, s[68:71], s9 offen offset:3072 lds
 s_mov_b32 s9, s60
 s_mov_b32 s62, 0x358637bd
 v_mov_b32 v48, s62
 v_mov_b32 v49, s62
 v_mov_b32 v50, s62
 v_mov_b32 v51, s62
 v_mov_b32 v52, s62
 v_mov_b32 v53, s62
 v_mov_b32 v54, s62
 v_mov_b32 v55, s62
 v_mov_b32 v56, s62
 v_mov_b32 v57, s62
 v_mov_b32 v58, s62
 v_mov_b32 v59, s62
 ds_read_b128 v[128:131], v12 offset:32768
 ds_read_b128 v[132:135], v13 offset:32768
 ds_read_b128 v[136:139], v14 offset:32768
 ds_read_b128 v[140:143], v15 offset:32768
 s_waitcnt vmcnt(13) lgkmcnt(0)
 s_barrier
 s_add_u32 m0, s13, 86016
 s_add_u32 s60, s10, 245760
 buffer_load_dwordx4 v2, s[72:75], s10 offen offset:0 lds
 buffer_load_dwordx4 v3, s[72:75], s10 offen offset:1024 lds
 buffer_load_dwordx4 v4, s[72:75], s10 offen offset:2048 lds
 buffer_load_dwordx4 v5, s[72:75], s10 offen offset:3072 lds
 s_add_u32 m0, m0, 4096
 s_cmp_ge_u32 s60, 2457600
 buffer_load_dwordx4 v6, s[72:75], s10 offen lds
 s_mov_b32 s10, s60
 s_add_u32 m0, s12, 32768
 s_add_u32 s60, s9, 128
 buffer_load_dwordx4 v8, s[68:71], s9 offen offset:0 lds
 buffer_load_dwordx4 v9, s[68:71], s9 offen offset:1024 lds
 buffer_load_dwordx4 v10, s[68:71], s9 offen offset:2048 lds
 buffer_load_dwordx4 v11, s[68:71], s9 offen offset:3072 lds
 s_mov_b32 s9, s60
 v_mov_b32 v60, s62
 v_mov_b32 v61, s62
 v_mov_b32 v62, s62
 v_mov_b32 v63, s62
 v_mov_b32 v64, s62
 v_mov_b32 v65, s62
 v_mov_b32 v66, s62
 v_mov_b32 v67, s62
 v_mov_b32 v68, s62
 v_mov_b32 v69, s62
 v_mov_b32 v70, s62
 v_mov_b32 v71, s62
 ds_read_b128 v[144:147], v12 offset:49152
 ds_read_b128 v[148:151], v13 offset:49152
 ds_read_b128 v[152:155], v14 offset:49152
 ds_read_b128 v[156:159], v15 offset:49152
 s_waitcnt vmcnt(13) lgkmcnt(0)
 s_barrier
 s_add_u32 m0, s13, 106496
 s_add_u32 s60, s10, 245760
 buffer_load_dwordx4 v2, s[72:75], s10 offen offset:0 lds
 buffer_load_dwordx4 v3, s[72:75], s10 offen offset:1024 lds
 buffer_load_dwordx4 v4, s[72:75], s10 offen offset:2048 lds
 buffer_load_dwordx4 v5, s[72:75], s10 offen offset:3072 lds
 s_add_u32 m0, m0, 4096
 s_cmp_ge_u32 s60, 2457600
 buffer_load_dwordx4 v6, s[72:75], s10 offen lds
 s_mov_b32 s10, s60
 s_add_u32 m0, s12, 49152
 s_add_u32 s60, s9, 128
 buffer_load_dwordx4 v8, s[68:71], s9 offen offset:0 lds
 buffer_load_dwordx4 v9, s[68:71], s9 offen offset:1024 lds
 buffer_load_dwordx4 v10, s[68:71], s9 offen offset:2048 lds
 buffer_load_dwordx4 v11, s[68:71], s9 offen offset:3072 lds
 s_mov_b32 s9, s60
 v_mov_b32 v72, s62
 v_mov_b32 v73, s62
 v_mov_b32 v74, s62
 v_mov_b32 v75, s62
 v_mov_b32 v76, s62
 v_mov_b32 v77, s62
 v_mov_b32 v78, s62
 v_mov_b32 v79, s62
 v_mov_b32 v80, s62
 v_mov_b32 v81, s62
 v_mov_b32 v82, s62
 v_mov_b32 v83, s62
 ds_read_b128 v[160:163], v12 offset:0
 ds_read_b128 v[164:167], v13 offset:0
 ds_read_b128 v[168:171], v14 offset:0
 ds_read_b128 v[172:175], v15 offset:0
 s_waitcnt vmcnt(13) lgkmcnt(0)
 s_barrier
 s_add_u32 m0, s13, 126976
 s_add_u32 s60, s10, 245760
 buffer_load_dwordx4 v2, s[72:75], s10 offen offset:0 lds
 buffer_load_dwordx4 v3, s[72:75], s10 offen offset:1024 lds
 buffer_load_dwordx4 v4, s[72:75], s10 offen offset:2048 lds
 buffer_load_dwordx4 v5, s[72:75], s10 offen offset:3072 lds
 s_add_u32 m0, m0, 4096
 s_cmp_ge_u32 s60, 2457600
 buffer_load_dwordx4 v6, s[72:75], s10 offen lds
 s_mov_b32 s10, s60
 s_add_u32 m0, s12, 0
 s_add_u32 s60, s9, 128
 buffer_load_dwordx4 v8, s[68:71], s9 offen offset:0 lds
 buffer_load_dwordx4 v9, s[68:71], s9 offen offset:1024 lds
 buffer_load_dwordx4 v10, s[68:71], s9 offen offset:2048 lds
 buffer_load_dwordx4 v11, s[68:71], s9 offen offset:3072 lds
 s_mov_b32 s9, s60
 v_mov_b32 v84, s62
 v_mov_b32 v85, s62
 v_mov_b32 v86, s62
 v_mov_b32 v87, s62
 v_mov_b32 v88, s62
 v_mov_b32 v89, s62
 v_mov_b32 v90, s62
 v_mov_b32 v91, s62
 v_mov_b32 v92, s62
 v_mov_b32 v93, s62
 v_mov_b32 v94, s62
 v_mov_b32 v95, s62
 ds_read_b128 v[176:179], v12 offset:16384
 ds_read_b128 v[180:183], v13 offset:16384
 ds_read_b128 v[184:187], v14 offset:16384
 ds_read_b128 v[188:191], v15 offset:16384
 s_waitcnt vmcnt(13) lgkmcnt(0)
 s_barrier
 s_add_u32 m0, s13, 65536
 s_add_u32 s60, s10, 245760
 buffer_load_dwordx4 v2, s[72:75], s10 offen offset:0 lds
 buffer_load_dwordx4 v3, s[72:75], s10 offen offset:1024 lds
 buffer_load_dwordx4 v4, s[72:75], s10 offen offset:2048 lds
 buffer_load_dwordx4 v5, s[72:75], s10 offen offset:3072 lds
 s_add_u32 m0, m0, 4096
 s_cmp_ge_u32 s60, 2457600
 buffer_load_dwordx4 v6, s[72:75], s10 offen lds
 s_mov_b32 s10, s60
 s_add_u32 m0, s12, 16384
 s_add_u32 s60, s9, 128
 buffer_load_dwordx4 v8, s[68:71], s9 offen offset:0 lds
 buffer_load_dwordx4 v9, s[68:71], s9 offen offset:1024 lds
 buffer_load_dwordx4 v10, s[68:71], s9 offen offset:2048 lds
 buffer_load_dwordx4 v11, s[68:71], s9 offen offset:3072 lds
 s_mov_b32 s9, s60
 ds_read_b128 v[192:195], v12 offset:32768
 ds_read_b128 v[196:199], v13 offset:32768
 ds_read_b128 v[200:203], v14 offset:32768
 ds_read_b128 v[204:207], v15 offset:32768
 s_waitcnt vmcnt(13) lgkmcnt(0)
 s_barrier
 s_add_u32 m0, s13, 86016
 s_add_u32 s60, s10, 245760
 buffer_load_dwordx4 v2, s[72:75], s10 offen offset:0 lds
 buffer_load_dwordx4 v3, s[72:75], s10 offen offset:1024 lds
 buffer_load_dwordx4 v4, s[72:75], s10 offen offset:2048 lds
 buffer_load_dwordx4 v5, s[72:75], s10 offen offset:3072 lds
 s_add_u32 m0, m0, 4096
 s_cmp_ge_u32 s60, 2457600
 buffer_load_dwordx4 v6, s[72:75], s10 offen lds
 s_cselect_b32 s10, 2457600, 0
 s_sub_u32 s10, s60, s10
 v_lshrrev_b32 v32, 24, v40
 v_and_b32 v40, 0xffff, v40
 v_lshrrev_b32 v33, 24, v41
 v_and_b32 v41, 0xffff, v41
 v_lshrrev_b32 v34, 24, v42
 v_and_b32 v42, 0xffff, v42
 v_lshrrev_b32 v35, 24, v43
 v_and_b32 v43, 0xffff, v43
 v_lshrrev_b32 v36, 24, v44
 v_and_b32 v44, 0xffff, v44
 v_mad_u32_u24 v2, v32, s65, v40
 v_mad_u32_u24 v3, v33, s65, v41
 v_mad_u32_u24 v4, v34, s65, v42
 v_mad_u32_u24 v5, v35, s65, v43
 v_mad_u32_u24 v6, v36, s65, v44
 ds_read_b128 v[208:211], v12 offset:49152
 ds_read_b128 v[212:215], v13 offset:49152
 ds_read_b128 v[216:219], v14 offset:49152
 ds_read_b128 v[220:223], v15 offset:49152
 s_waitcnt vmcnt(9) lgkmcnt(0)
 s_barrier
 s_add_u32 m0, s13, 106496
 s_add_u32 s60, s16, 491520
 buffer_load_dwordx4 v2, s[72:75], s16 offen offset:0 lds
 buffer_load_dwordx4 v3, s[72:75], s16 offen offset:1024 lds
 buffer_load_dwordx4 v4, s[72:75], s16 offen offset:2048 lds
 buffer_load_dwordx4 v5, s[72:75], s16 offen offset:3072 lds
 s_add_u32 m0, m0, 4096
 s_cmp_ge_u32 s60, 2457600
 buffer_load_dwordx4 v6, s[72:75], s16 offen lds
 s_mov_b32 s16, s60
 s_add_u32 m0, s13, 126976
 s_add_u32 s60, s16, 491520
 buffer_load_dwordx4 v2, s[72:75], s16 offen offset:0 lds
 buffer_load_dwordx4 v3, s[72:75], s16 offen offset:1024 lds
 buffer_load_dwordx4 v4, s[72:75], s16 offen offset:2048 lds
 buffer_load_dwordx4 v5, s[72:75], s16 offen offset:3072 lds
 s_add_u32 m0, m0, 4096
 s_cmp_ge_u32 s60, 2457600
 buffer_load_dwordx4 v6, s[72:75], s16 offen lds
 s_mov_b32 s16, s60
 ds_read_b128 v[224:227], v12 offset:0
 ds_read_b128 v[228:231], v13 offset:0
 ds_read_b128 v[232:235], v14 offset:0
 ds_read_b128 v[236:239], v15 offset:0
 s_waitcnt vmcnt(10) lgkmcnt(0)
 s_barrier
 ds_read_b128 v[240:243], v12 offset:16384
 ds_read_b128 v[244:247], v13 offset:16384
 ds_read_b128 v[248:251], v14 offset:16384
 ds_read_b128 v[252:255], v15 offset:16384
 s_waitcnt vmcnt(5) lgkmcnt(0)
 s_barrier
 s_add_u32 m0, s13, 45056
 s_add_u32 s60, s16, 491520
 buffer_load_dwordx4 v2, s[72:75], s16 offen offset:0 lds
 buffer_load_dwordx4 v3, s[72:75], s16 offen offset:1024 lds
 buffer_load_dwordx4 v4, s[72:75], s16 offen offset:2048 lds
 buffer_load_dwordx4 v5, s[72:75], s16 offen offset:3072 lds
 s_add_u32 m0, m0, 4096
 s_cmp_ge_u32 s60, 2457600
 buffer_load_dwordx4 v6, s[72:75], s16 offen lds
 s_cselect_b32 s16, 2457600, 0
 s_sub_u32 s16, s60, s16
 v_mov_b32 v22, 160764
 v_mov_b32 v23, 1
 ds_read_b64_tr_b16 v[24:25], v17 offset:40960
 ds_read_b64_tr_b16 v[26:27], v17 offset:41120
 ds_read_b64_tr_b16 v[28:29], v17 offset:41024
 ds_read_b64_tr_b16 v[30:31], v17 offset:41184
 ds_read_b64_tr_b16 v[32:33], v17 offset:41088
 ds_read_b64_tr_b16 v[34:35], v17 offset:41248
 ds_read_b64_tr_b16 v[36:37], v17 offset:43520
 ds_read_b64_tr_b16 v[38:39], v17 offset:43680
 ds_read_b64_tr_b16 v[40:41], v17 offset:43584
 ds_read_b64_tr_b16 v[42:43], v17 offset:43744
 ds_read_b64_tr_b16 v[44:45], v17 offset:43648
 ds_read_b64_tr_b16 v[46:47], v17 offset:43808
 s_waitcnt lgkmcnt(8)
 v_mfma_f32_32x32x16_bf16 v[48:63], v[24:27], v[96:99], v[48:63]
 ds_read_b64_tr_b16 v[24:25], v17 offset:46080
 ds_read_b64_tr_b16 v[26:27], v17 offset:46240
 v_mfma_f32_32x32x16_bf16 v[64:79], v[28:31], v[96:99], v[64:79]
 ds_read_b64_tr_b16 v[28:29], v17 offset:46144
 ds_read_b64_tr_b16 v[30:31], v17 offset:46304
 s_waitcnt lgkmcnt(8)
 v_mfma_f32_32x32x16_bf16 v[80:95], v[32:35], v[96:99], v[80:95]
 ds_read_b64_tr_b16 v[32:33], v17 offset:46208
 ds_read_b64_tr_b16 v[34:35], v17 offset:46368
 v_mfma_f32_32x32x16_bf16 v[48:63], v[36:39], v[100:103], v[48:63]
 ds_read_b64_tr_b16 v[36:37], v17 offset:48640
 ds_read_b64_tr_b16 v[38:39], v17 offset:48800
 s_waitcnt lgkmcnt(8)
 v_mfma_f32_32x32x16_bf16 v[64:79], v[40:43], v[100:103], v[64:79]
 ds_read_b64_tr_b16 v[40:41], v17 offset:48704
 ds_read_b64_tr_b16 v[42:43], v17 offset:48864
 v_mfma_f32_32x32x16_bf16 v[80:95], v[44:47], v[100:103], v[80:95]
 ds_read_b64_tr_b16 v[44:45], v17 offset:48768
 ds_read_b64_tr_b16 v[46:47], v17 offset:48928
 s_waitcnt lgkmcnt(8)
 v_mfma_f32_32x32x16_bf16 v[48:63], v[24:27], v[104:107], v[48:63]
 ds_read_b64_tr_b16 v[24:25], v17 offset:51200
 ds_read_b64_tr_b16 v[26:27], v17 offset:51360
 v_mfma_f32_32x32x16_bf16 v[64:79], v[28:31], v[104:107], v[64:79]
 ds_read_b64_tr_b16 v[28:29], v17 offset:51264
 ds_read_b64_tr_b16 v[30:31], v17 offset:51424
 s_waitcnt lgkmcnt(8)
 v_mfma_f32_32x32x16_bf16 v[80:95], v[32:35], v[104:107], v[80:95]
 ds_read_b64_tr_b16 v[32:33], v17 offset:51328
 ds_read_b64_tr_b16 v[34:35], v17 offset:51488
 v_mfma_f32_32x32x16_bf16 v[48:63], v[36:39], v[108:111], v[48:63]
 ds_read_b64_tr_b16 v[36:37], v17 offset:53760
 ds_read_b64_tr_b16 v[38:39], v17 offset:53920
 s_waitcnt vmcnt(5)
 s_mov_b64 exec, 1
 ds_add_u32 v22, v23
 s_mov_b64 exec, -1
 s_waitcnt lgkmcnt(8)
 v_mfma_f32_32x32x16_bf16 v[64:79], v[40:43], v[108:111], v[64:79]
 ds_read_b64_tr_b16 v[40:41], v17 offset:53824
 ds_read_b64_tr_b16 v[42:43], v17 offset:53984
 s_add_u32 m0, s13, 0
 s_add_u32 s60, s16, 491520
 buffer_load_dwordx4 v2, s[72:75], s16 offen offset:0 lds
 buffer_load_dwordx4 v3, s[72:75], s16 offen offset:1024 lds
 buffer_load_dwordx4 v4, s[72:75], s16 offen offset:2048 lds
 buffer_load_dwordx4 v5, s[72:75], s16 offen offset:3072 lds
 s_add_u32 m0, m0, 4096
 s_cmp_ge_u32 s60, 2457600
 buffer_load_dwordx4 v6, s[72:75], s16 offen lds
 s_cselect_b32 s16, 2457600, 0
 s_sub_u32 s16, s60, s16
 v_mfma_f32_32x32x16_bf16 v[80:95], v[44:47], v[108:111], v[80:95]
 ds_read_b64_tr_b16 v[44:45], v17 offset:53888
 ds_read_b64_tr_b16 v[46:47], v17 offset:54048
 s_waitcnt lgkmcnt(8)
 v_mfma_f32_32x32x16_bf16 v[48:63], v[24:27], v[112:115], v[48:63]
 ds_read_b64_tr_b16 v[24:25], v17 offset:56320
 ds_read_b64_tr_b16 v[26:27], v17 offset:56480
 v_mfma_f32_32x32x16_bf16 v[64:79], v[28:31], v[112:115], v[64:79]
 ds_read_b64_tr_b16 v[28:29], v17 offset:56384
 ds_read_b64_tr_b16 v[30:31], v17 offset:56544
 s_waitcnt lgkmcnt(8)
 v_mfma_f32_32x32x16_bf16 v[80:95], v[32:35], v[112:115], v[80:95]
 ds_read_b64_tr_b16 v[32:33], v17 offset:56448
 ds_read_b64_tr_b16 v[34:35], v17 offset:56608
 v_mfma_f32_32x32x16_bf16 v[48:63], v[36:39], v[116:119], v[48:63]
 ds_read_b64_tr_b16 v[36:37], v17 offset:58880
 ds_read_b64_tr_b16 v[38:39], v17 offset:59040
 s_waitcnt lgkmcnt(8)
 v_mfma_f32_32x32x16_bf16 v[64:79], v[40:43], v[116:119], v[64:79]
 ds_read_b64_tr_b16 v[40:41], v17 offset:58944
 ds_read_b64_tr_b16 v[42:43], v17 offset:59104
 v_mfma_f32_32x32x16_bf16 v[80:95], v[44:47], v[116:119], v[80:95]
 ds_read_b64_tr_b16 v[44:45], v17 offset:59008
 ds_read_b64_tr_b16 v[46:47], v17 offset:59168
 s_waitcnt lgkmcnt(8)
 v_mfma_f32_32x32x16_bf16 v[48:63], v[24:27], v[120:123], v[48:63]
LB_ls1:
 ds_read_b32 v21, v22
 s_waitcnt lgkmcnt(0)
 v_readfirstlane_b32 s61, v21
 s_nop 0
 s_cmp_lt_u32 s61, 4
 s_cbranch_scc1 LB_ls1
 ds_read_b64_tr_b16 v[24:25], v17 offset:61440
 ds_read_b64_tr_b16 v[26:27], v17 offset:61600
 v_mfma_f32_32x32x16_bf16 v[64:79], v[28:31], v[120:123], v[64:79]
 ds_read_b64_tr_b16 v[28:29], v17 offset:61504
 ds_read_b64_tr_b16 v[30:31], v17 offset:61664
 s_waitcnt lgkmcnt(8)
 v_mfma_f32_32x32x16_bf16 v[80:95], v[32:35], v[120:123], v[80:95]
 ds_read_b64_tr_b16 v[32:33], v17 offset:61568
 ds_read_b64_tr_b16 v[34:35], v17 offset:61728
 v_mfma_f32_32x32x16_bf16 v[48:63], v[36:39], v[124:127], v[48:63]
 ds_read_b64_tr_b16 v[36:37], v17 offset:64000
 ds_read_b64_tr_b16 v[38:39], v17 offset:64160
 s_waitcnt lgkmcnt(8)
 v_mfma_f32_32x32x16_bf16 v[64:79], v[40:43], v[124:127], v[64:79]
 ds_read_b64_tr_b16 v[40:41], v17 offset:64064
 ds_read_b64_tr_b16 v[42:43], v17 offset:64224
 s_add_u32 m0, s13, 20480
 s_add_u32 s60, s16, 491520
 buffer_load_dwordx4 v2, s[72:75], s16 offen offset:0 lds
 buffer_load_dwordx4 v3, s[72:75], s16 offen offset:1024 lds
 buffer_load_dwordx4 v4, s[72:75], s16 offen offset:2048 lds
 buffer_load_dwordx4 v5, s[72:75], s16 offen offset:3072 lds
 s_add_u32 m0, m0, 4096
 s_cmp_ge_u32 s60, 2457600
 buffer_load_dwordx4 v6, s[72:75], s16 offen lds
 s_cselect_b32 s16, 2457600, 0
 s_sub_u32 s16, s60, s16
 v_mfma_f32_32x32x16_bf16 v[80:95], v[44:47], v[124:127], v[80:95]
 ds_read_b64_tr_b16 v[44:45], v17 offset:64128
 ds_read_b64_tr_b16 v[46:47], v17 offset:64288
 s_waitcnt lgkmcnt(8)
 v_mfma_f32_32x32x16_bf16 v[48:63], v[24:27], v[128:131], v[48:63]
 ds_read_b64_tr_b16 v[24:25], v18 offset:1024
 ds_read_b64_tr_b16 v[26:27], v18 offset:1184
 v_mfma_f32_32x32x16_bf16 v[64:79], v[28:31], v[128:131], v[64:79]
 ds_read_b64_tr_b16 v[28:29], v18 offset:1088
 ds_read_b64_tr_b16 v[30:31], v18 offset:1248
 s_waitcnt vmcnt(10)
 s_mov_b64 exec, 1
 ds_add_u32 v22, v23
 s_mov_b64 exec, -1
 s_waitcnt lgkmcnt(8)
 v_mfma_f32_32x32x16_bf16 v[80:95], v[32:35], v[128:131], v[80:95]
 ds_read_b64_tr_b16 v[32:33], v18 offset:1152
 ds_read_b64_tr_b16 v[34:35], v18 offset:1312
 v_mfma_f32_32x32x16_bf16 v[48:63], v[36:39], v[132:135], v[48:63]
 ds_read_b64_tr_b16 v[36:37], v18 offset:3584
 ds_read_b64_tr_b16 v[38:39], v18 offset:3744
 s_waitcnt lgkmcnt(8)
 v_mfma_f32_32x32x16_bf16 v[64:79], v[40:43], v[132:135], v[64:79]
 ds_read_b64_tr_b16 v[40:41], v18 offset:3648
 ds_read_b64_tr_b16 v[42:43], v18 offset:3808
 v_mfma_f32_32x32x16_bf16 v[80:95], v[44:47], v[132:135], v[80:95]
 ds_read_b64_tr_b16 v[44:45], v18 offset:3712
 ds_read_b64_tr_b16 v[46:47], v18 offset:3872
 s_waitcnt lgkmcnt(8)
 v_mfma_f32_32x32x16_bf16 v[48:63], v[24:27], v[136:139], v[48:63]
 ds_read_b64_tr_b16 v[24:25], v18 offset:6144
 ds_read_b64_tr_b16 v[26:27], v18 offset:6304
 v_mfma_f32_32x32x16_bf16 v[64:79], v[28:31], v[136:139], v[64:79]
 ds_read_b64_tr_b16 v[28:29], v18 offset:8704
 ds_read_b64_tr_b16 v[30:31], v18 offset:8864
 s_waitcnt lgkmcnt(8)
 v_mfma_f32_32x32x16_bf16 v[80:95], v[32:35], v[136:139], v[80:95]
 ds_read_b64_tr_b16 v[32:33], v18 offset:11264
 ds_read_b64_tr_b16 v[34:35], v18 offset:11424
 v_mfma_f32_32x32x16_bf16 v[48:63], v[36:39], v[140:143], v[48:63]
 ds_read_b64_tr_b16 v[36:37], v18 offset:13824
 ds_read_b64_tr_b16 v[38:39], v18 offset:13984
 s_waitcnt lgkmcnt(8)
 v_mfma_f32_32x32x16_bf16 v[64:79], v[40:43], v[140:143], v[64:79]
LB_ls2:
 ds_read_b32 v21, v22
 s_waitcnt lgkmcnt(0)
 v_readfirstlane_b32 s61, v21
 s_nop 0
 s_cmp_lt_u32 s61, 8
 s_cbranch_scc1 LB_ls2
 ds_read_b64_tr_b16 v[40:41], v16 offset:45056
 ds_read_b64_tr_b16 v[42:43], v16 offset:45216
 v_mfma_f32_32x32x16_bf16 v[80:95], v[44:47], v[140:143], v[80:95]
 ds_read_b64_tr_b16 v[44:45], v16 offset:47616
 ds_read_b64_tr_b16 v[46:47], v16 offset:47776
 s_waitcnt lgkmcnt(8)
 v_mfma_f32_32x32x16_bf16 v[48:63], v[24:27], v[144:147], v[48:63]
 ds_read_b64_tr_b16 v[24:25], v16 offset:50176
 ds_read_b64_tr_b16 v[26:27], v16 offset:50336
 v_mfma_f32_32x32x16_bf16 v[48:63], v[28:31], v[148:151], v[48:63]
 ds_read_b64_tr_b16 v[28:29], v16 offset:52736
 ds_read_b64_tr_b16 v[30:31], v16 offset:52896
 s_waitcnt vmcnt(0)
 s_mov_b64 exec, 1
 ds_add_u32 v22, v23
 s_mov_b64 exec, -1
 s_waitcnt lgkmcnt(8)
 v_mfma_f32_32x32x16_bf16 v[48:63], v[32:35], v[152:155], v[48:63]
 ds_read_b64_tr_b16 v[32:33], v16 offset:55296
 ds_read_b64_tr_b16 v[34:35], v16 offset:55456
 v_mfma_f32_32x32x16_bf16 v[48:63], v[36:39], v[156:159], v[48:63]
 ds_read_b64_tr_b16 v[36:37], v16 offset:57856
 ds_read_b64_tr_b16 v[38:39], v16 offset:58016
 s_waitcnt lgkmcnt(8)
 v_mfma_f32_32x32x16_bf16 v[48:63], v[40:43], v[160:163], v[48:63]
 ds_read_b64_tr_b16 v[40:41], v16 offset:60416
 ds_read_b64_tr_b16 v[42:43], v16 offset:60576
 v_mfma_f32_32x32x16_bf16 v[48:63], v[44:47], v[164:167], v[48:63]
 ds_read_b64_tr_b16 v[44:45], v16 offset:62976
 ds_read_b64_tr_b16 v[46:47], v16 offset:63136
 s_waitcnt lgkmcnt(8)
 v_mfma_f32_32x32x16_bf16 v[48:63], v[24:27], v[168:171], v[48:63]
LB_ls3:
 ds_read_b32 v21, v22
 s_waitcnt lgkmcnt(0)
 v_readfirstlane_b32 s61, v21
 s_nop 0
 s_cmp_lt_u32 s61, 12
 s_cbranch_scc1 LB_ls3
 ds_read_b64_tr_b16 v[24:25], v16 offset:0
 ds_read_b64_tr_b16 v[26:27], v16 offset:160
 v_mfma_f32_32x32x16_bf16 v[48:63], v[28:31], v[172:175], v[48:63]
 ds_read_b64_tr_b16 v[28:29], v16 offset:2560
 ds_read_b64_tr_b16 v[30:31], v16 offset:2720
 s_waitcnt lgkmcnt(8)
 v_mfma_f32_32x32x16_bf16 v[48:63], v[32:35], v[176:179], v[48:63]
 ds_read_b64_tr_b16 v[32:33], v16 offset:5120
 ds_read_b64_tr_b16 v[34:35], v16 offset:5280
 v_mfma_f32_32x32x16_bf16 v[48:63], v[36:39], v[180:183], v[48:63]
 ds_read_b64_tr_b16 v[36:37], v16 offset:7680
 ds_read_b64_tr_b16 v[38:39], v16 offset:7840
 s_waitcnt lgkmcnt(8)
 v_mfma_f32_32x32x16_bf16 v[48:63], v[40:43], v[184:187], v[48:63]
 ds_read_b64_tr_b16 v[40:41], v16 offset:10240
 ds_read_b64_tr_b16 v[42:43], v16 offset:10400
 v_mfma_f32_32x32x16_bf16 v[48:63], v[44:47], v[188:191], v[48:63]
 ds_read_b64_tr_b16 v[44:45], v16 offset:12800
 ds_read_b64_tr_b16 v[46:47], v16 offset:12960
 s_waitcnt lgkmcnt(8)
 v_mfma_f32_32x32x16_bf16 v[48:63], v[24:27], v[192:195], v[48:63]
 ds_read_b64_tr_b16 v[24:25], v16 offset:15360
 ds_read_b64_tr_b16 v[26:27], v16 offset:15520
 v_mfma_f32_32x32x16_bf16 v[48:63], v[28:31], v[196:199], v[48:63]
 ds_read_b64_tr_b16 v[28:29], v16 offset:17920
 ds_read_b64_tr_b16 v[30:31], v16 offset:18080
 s_waitcnt lgkmcnt(8)
 v_mfma_f32_32x32x16_bf16 v[48:63], v[32:35], v[200:203], v[48:63]
 ds_read_b64_tr_b16 v[32:33], v16 offset:20480
 ds_read_b64_tr_b16 v[34:35], v16 offset:20640
 s_mov_b32 s60, 0x3fb8aa3b
 s_mov_b32 s62, 0x358637bd
 s_mov_b32 s80, s30
 s_mov_b32 s81, s31
 s_mov_b32 s82, 16777216
 s_mov_b32 s83, 0x20000
 v_mfma_f32_32x32x16_bf16 v[48:63], v[36:39], v[204:207], v[48:63]
 ds_read_b64_tr_b16 v[36:37], v16 offset:23040
 ds_read_b64_tr_b16 v[38:39], v16 offset:23200
 s_waitcnt lgkmcnt(8)
 v_mfma_f32_32x32x16_bf16 v[48:63], v[40:43], v[208:211], v[48:63]
 ds_read_b64_tr_b16 v[40:41], v16 offset:25600
 ds_read_b64_tr_b16 v[42:43], v16 offset:25760
 v_mfma_f32_32x32x16_bf16 v[48:63], v[44:47], v[212:215], v[48:63]
 ds_read_b64_tr_b16 v[44:45], v16 offset:28160
 ds_read_b64_tr_b16 v[46:47], v16 offset:28320
 s_waitcnt lgkmcnt(8)
 v_mfma_f32_32x32x16_bf16 v[48:63], v[24:27], v[216:219], v[48:63]
 ds_read_b64_tr_b16 v[24:25], v16 offset:30720
 ds_read_b64_tr_b16 v[26:27], v16 offset:30880
 v_mfma_f32_32x32x16_bf16 v[48:63], v[28:31], v[220:223], v[48:63]
 ds_read_b64_tr_b16 v[28:29], v16 offset:33280
 ds_read_b64_tr_b16 v[30:31], v16 offset:33440
 s_waitcnt lgkmcnt(8)
 v_mfma_f32_32x32x16_bf16 v[48:63], v[32:35], v[224:227], v[48:63]
 ds_read_b64_tr_b16 v[32:33], v16 offset:35840
 ds_read_b64_tr_b16 v[34:35], v16 offset:36000
 v_mfma_f32_32x32x16_bf16 v[48:63], v[36:39], v[228:231], v[48:63]
 ds_read_b64_tr_b16 v[36:37], v16 offset:38400
 ds_read_b64_tr_b16 v[38:39], v16 offset:38560
 s_waitcnt lgkmcnt(8)
 v_mfma_f32_32x32x16_bf16 v[48:63], v[40:43], v[232:235], v[48:63]
 ds_read_b64_tr_b16 v[40:41], v18 offset:6208
 ds_read_b64_tr_b16 v[42:43], v18 offset:6368
 v_mfma_f32_32x32x16_bf16 v[48:63], v[44:47], v[236:239], v[48:63]
 ds_read_b64_tr_b16 v[44:45], v18 offset:8768
 ds_read_b64_tr_b16 v[46:47], v18 offset:8928
 s_waitcnt lgkmcnt(8)
 v_mfma_f32_32x32x16_bf16 v[48:63], v[24:27], v[240:243], v[48:63]
 ds_read_b64_tr_b16 v[24:25], v18 offset:11328
 ds_read_b64_tr_b16 v[26:27], v18 offset:11488
 v_mfma_f32_32x32x16_bf16 v[48:63], v[28:31], v[244:247], v[48:63]
 ds_read_b64_tr_b16 v[28:29], v18 offset:13888
 ds_read_b64_tr_b16 v[30:31], v18 offset:14048
 s_waitcnt lgkmcnt(8)
 v_mfma_f32_32x32x16_bf16 v[48:63], v[32:35], v[248:251], v[48:63]
 ds_read_b64_tr_b16 v[32:33], v16 offset:45120
 ds_read_b64_tr_b16 v[34:35], v16 offset:45280
 v_mfma_f32_32x32x16_bf16 v[48:63], v[36:39], v[252:255], v[48:63]
 ds_read_b64_tr_b16 v[36:37], v16 offset:47680
 ds_read_b64_tr_b16 v[38:39], v16 offset:47840
 s_waitcnt lgkmcnt(8)
 v_mfma_f32_32x32x16_bf16 v[64:79], v[40:43], v[144:147], v[64:79]
 ds_read_b64_tr_b16 v[40:41], v16 offset:50240
 ds_read_b64_tr_b16 v[42:43], v16 offset:50400
 v_mfma_f32_32x32x16_bf16 v[64:79], v[44:47], v[148:151], v[64:79]
 ds_read_b64_tr_b16 v[44:45], v16 offset:52800
 ds_read_b64_tr_b16 v[46:47], v16 offset:52960
 s_waitcnt lgkmcnt(8)
 v_mfma_f32_32x32x16_bf16 v[64:79], v[24:27], v[152:155], v[64:79]
 ds_read_b64_tr_b16 v[24:25], v16 offset:55360
 ds_read_b64_tr_b16 v[26:27], v16 offset:55520
 v_mfma_f32_32x32x16_bf16 v[64:79], v[28:31], v[156:159], v[64:79]
 ds_read_b64_tr_b16 v[28:29], v16 offset:57920
 ds_read_b64_tr_b16 v[30:31], v16 offset:58080
 v_mul_f32 v2, s60, v48
 v_mul_f32 v3, s60, v49
 v_mul_f32 v4, s60, v50
 s_waitcnt lgkmcnt(8)
 v_mfma_f32_32x32x16_bf16 v[64:79], v[32:35], v[160:163], v[64:79]
 ds_read_b64_tr_b16 v[32:33], v16 offset:60480
 ds_read_b64_tr_b16 v[34:35], v16 offset:60640
 v_mul_f32 v5, s60, v51
 v_mul_f32 v6, s60, v52
 v_mul_f32 v7, s60, v53
 v_mfma_f32_32x32x16_bf16 v[64:79], v[36:39], v[164:167], v[64:79]
 ds_read_b64_tr_b16 v[36:37], v16 offset:63040
 ds_read_b64_tr_b16 v[38:39], v16 offset:63200
 v_mul_f32 v8, s60, v54
 v_mul_f32 v9, s60, v55
 v_exp_f32 v2, v2 clamp
 s_waitcnt lgkmcnt(8)
 v_mfma_f32_32x32x16_bf16 v[64:79], v[40:43], v[168:171], v[64:79]
 ds_read_b64_tr_b16 v[40:41], v16 offset:64
 ds_read_b64_tr_b16 v[42:43], v16 offset:224
 v_max_f32 v48, s62, v48
 v_exp_f32 v3, v3 clamp
 v_max_f32 v49, s62, v49
 v_mfma_f32_32x32x16_bf16 v[64:79], v[44:47], v[172:175], v[64:79]
 ds_read_b64_tr_b16 v[44:45], v16 offset:2624
 ds_read_b64_tr_b16 v[46:47], v16 offset:2784
 v_exp_f32 v4, v4 clamp
 v_max_f32 v50, s62, v50
 v_exp_f32 v5, v5 clamp
 s_waitcnt lgkmcnt(8)
 v_mfma_f32_32x32x16_bf16 v[64:79], v[24:27], v[176:179], v[64:79]
 ds_read_b64_tr_b16 v[24:25], v16 offset:5184
 ds_read_b64_tr_b16 v[26:27], v16 offset:5344
 v_max_f32 v51, s62, v51
 v_exp_f32 v6, v6 clamp
 v_max_f32 v52, s62, v52
 v_mfma_f32_32x32x16_bf16 v[64:79], v[28:31], v[180:183], v[64:79]
 ds_read_b64_tr_b16 v[28:29], v16 offset:7744
 ds_read_b64_tr_b16 v[30:31], v16 offset:7904
 v_exp_f32 v7, v7 clamp
 v_max_f32 v53, s62, v53
 v_exp_f32 v8, v8 clamp
 s_waitcnt lgkmcnt(8)
 v_mfma_f32_32x32x16_bf16 v[64:79], v[32:35], v[184:187], v[64:79]
 ds_read_b64_tr_b16 v[32:33], v16 offset:10304
 ds_read_b64_tr_b16 v[34:35], v16 offset:10464
 v_max_f32 v54, s62, v54
 v_exp_f32 v9, v9 clamp
 v_max_f32 v55, s62, v55
 v_mfma_f32_32x32x16_bf16 v[64:79], v[36:39], v[188:191], v[64:79]
 ds_read_b64_tr_b16 v[36:37], v16 offset:12864
 ds_read_b64_tr_b16 v[38:39], v16 offset:13024
 v_add_f32 v48, v48, v2
 v_add_f32 v49, v49, v3
 v_add_f32 v50, v50, v4
 s_waitcnt lgkmcnt(8)
 v_mfma_f32_32x32x16_bf16 v[64:79], v[40:43], v[192:195], v[64:79]
 ds_read_b64_tr_b16 v[40:41], v16 offset:15424
 ds_read_b64_tr_b16 v[42:43], v16 offset:15584
 v_add_f32 v51, v51, v5
 v_add_f32 v52, v52, v6
 v_add_f32 v53, v53, v7
 v_mfma_f32_32x32x16_bf16 v[64:79], v[44:47], v[196:199], v[64:79]
 ds_read_b64_tr_b16 v[44:45], v16 offset:17984
 ds_read_b64_tr_b16 v[46:47], v16 offset:18144
 v_add_f32 v54, v54, v8
 v_add_f32 v55, v55, v9
 v_mul_f32 v2, s60, v56
 s_waitcnt lgkmcnt(8)
 v_mfma_f32_32x32x16_bf16 v[64:79], v[24:27], v[200:203], v[64:79]
 ds_read_b64_tr_b16 v[24:25], v16 offset:20544
 ds_read_b64_tr_b16 v[26:27], v16 offset:20704
 v_mul_f32 v3, s60, v57
 v_mul_f32 v4, s60, v58
 v_mul_f32 v5, s60, v59
 v_mfma_f32_32x32x16_bf16 v[64:79], v[28:31], v[204:207], v[64:79]
 ds_read_b64_tr_b16 v[28:29], v16 offset:23104
 ds_read_b64_tr_b16 v[30:31], v16 offset:23264
 v_mul_f32 v6, s60, v60
 v_mul_f32 v7, s60, v61
 v_mul_f32 v8, s60, v62
 s_waitcnt lgkmcnt(8)
 v_mfma_f32_32x32x16_bf16 v[64:79], v[32:35], v[208:211], v[64:79]
 ds_read_b64_tr_b16 v[32:33], v16 offset:25664
 ds_read_b64_tr_b16 v[34:35], v16 offset:25824
 v_mul_f32 v9, s60, v63
 v_exp_f32 v2, v2 clamp
 v_max_f32 v56, s62, v56
 v_mfma_f32_32x32x16_bf16 v[64:79], v[36:39], v[212:215], v[64:79]
 ds_read_b64_tr_b16 v[36:37], v16 offset:28224
 ds_read_b64_tr_b16 v[38:39], v16 offset:28384
 v_exp_f32 v3, v3 clamp
 v_max_f32 v57, s62, v57
 v_exp_f32 v4, v4 clamp
 s_waitcnt lgkmcnt(8)
 v_mfma_f32_32x32x16_bf16 v[64:79], v[40:43], v[216:219], v[64:79]
 ds_read_b64_tr_b16 v[40:41], v16 offset:30784
 ds_read_b64_tr_b16 v[42:43], v16 offset:30944
 v_max_f32 v58, s62, v58
 v_exp_f32 v5, v5 clamp
 v_max_f32 v59, s62, v59
 v_mfma_f32_32x32x16_bf16 v[64:79], v[44:47], v[220:223], v[64:79]
 ds_read_b64_tr_b16 v[44:45], v16 offset:33344
 ds_read_b64_tr_b16 v[46:47], v16 offset:33504
 v_exp_f32 v6, v6 clamp
 v_max_f32 v60, s62, v60
 v_exp_f32 v7, v7 clamp
 s_waitcnt lgkmcnt(8)
 v_mfma_f32_32x32x16_bf16 v[64:79], v[24:27], v[224:227], v[64:79]
 ds_read_b64_tr_b16 v[24:25], v16 offset:35904
 ds_read_b64_tr_b16 v[26:27], v16 offset:36064
 v_max_f32 v61, s62, v61
 v_exp_f32 v8, v8 clamp
 v_max_f32 v62, s62, v62
 v_mfma_f32_32x32x16_bf16 v[64:79], v[28:31], v[228:231], v[64:79]
 ds_read_b64_tr_b16 v[28:29], v16 offset:38464
 ds_read_b64_tr_b16 v[30:31], v16 offset:38624
 v_exp_f32 v9, v9 clamp
 v_max_f32 v63, s62, v63
 v_add_f32 v56, v56, v2
 s_waitcnt lgkmcnt(8)
 v_mfma_f32_32x32x16_bf16 v[64:79], v[32:35], v[232:235], v[64:79]
 ds_read_b64_tr_b16 v[32:33], v18 offset:6272
 ds_read_b64_tr_b16 v[34:35], v18 offset:6432
 v_add_f32 v57, v57, v3
 v_add_f32 v58, v58, v4
 v_add_f32 v59, v59, v5
 v_mfma_f32_32x32x16_bf16 v[64:79], v[36:39], v[236:239], v[64:79]
 ds_read_b64_tr_b16 v[36:37], v18 offset:8832
 ds_read_b64_tr_b16 v[38:39], v18 offset:8992
 v_add_f32 v60, v60, v6
 v_add_f32 v61, v61, v7
 v_add_f32 v62, v62, v8
 s_waitcnt lgkmcnt(8)
 v_mfma_f32_32x32x16_bf16 v[64:79], v[40:43], v[240:243], v[64:79]
 ds_read_b64_tr_b16 v[40:41], v18 offset:11392
 ds_read_b64_tr_b16 v[42:43], v18 offset:11552
 v_add_f32 v63, v63, v9
 v_cvt_pk_bf16_f32 v96, v48, v49
 v_cvt_pk_bf16_f32 v97, v50, v51
 v_mfma_f32_32x32x16_bf16 v[64:79], v[44:47], v[244:247], v[64:79]
 ds_read_b64_tr_b16 v[44:45], v18 offset:13952
 ds_read_b64_tr_b16 v[46:47], v18 offset:14112
 v_cvt_pk_bf16_f32 v98, v52, v53
 v_cvt_pk_bf16_f32 v99, v54, v55
 v_cvt_pk_bf16_f32 v100, v56, v57
 s_waitcnt lgkmcnt(8)
 v_mfma_f32_32x32x16_bf16 v[64:79], v[24:27], v[248:251], v[64:79]
 ds_read_b64_tr_b16 v[24:25], v16 offset:45184
 ds_read_b64_tr_b16 v[26:27], v16 offset:45344
 v_cvt_pk_bf16_f32 v101, v58, v59
 v_cvt_pk_bf16_f32 v102, v60, v61
 v_cvt_pk_bf16_f32 v103, v62, v63
 v_mfma_f32_32x32x16_bf16 v[64:79], v[28:31], v[252:255], v[64:79]
 ds_read_b64_tr_b16 v[28:29], v16 offset:47744
 ds_read_b64_tr_b16 v[30:31], v16 offset:47904
 s_waitcnt lgkmcnt(8)
 v_mfma_f32_32x32x16_bf16 v[80:95], v[32:35], v[144:147], v[80:95]
 ds_read_b64_tr_b16 v[32:33], v16 offset:50304
 ds_read_b64_tr_b16 v[34:35], v16 offset:50464
 v_mfma_f32_32x32x16_bf16 v[80:95], v[36:39], v[148:151], v[80:95]
 ds_read_b64_tr_b16 v[36:37], v16 offset:52864
 ds_read_b64_tr_b16 v[38:39], v16 offset:53024
 s_waitcnt lgkmcnt(8)
 v_mfma_f32_32x32x16_bf16 v[80:95], v[40:43], v[152:155], v[80:95]
 ds_read_b64_tr_b16 v[40:41], v16 offset:55424
 ds_read_b64_tr_b16 v[42:43], v16 offset:55584
 v_mfma_f32_32x32x16_bf16 v[80:95], v[44:47], v[156:159], v[80:95]
 ds_read_b64_tr_b16 v[44:45], v16 offset:57984
 ds_read_b64_tr_b16 v[46:47], v16 offset:58144
 v_mul_f32 v2, s60, v64
 v_mul_f32 v3, s60, v65
 v_mul_f32 v4, s60, v66
 s_waitcnt lgkmcnt(8)
 v_mfma_f32_32x32x16_bf16 v[80:95], v[24:27], v[160:163], v[80:95]
 ds_read_b64_tr_b16 v[24:25], v16 offset:60544
 ds_read_b64_tr_b16 v[26:27], v16 offset:60704
 v_mul_f32 v5, s60, v67
 v_mul_f32 v6, s60, v68
 v_mul_f32 v7, s60, v69
 v_mfma_f32_32x32x16_bf16 v[80:95], v[28:31], v[164:167], v[80:95]
 ds_read_b64_tr_b16 v[28:29], v16 offset:63104
 ds_read_b64_tr_b16 v[30:31], v16 offset:63264
 v_mul_f32 v8, s60, v70
 v_mul_f32 v9, s60, v71
 v_exp_f32 v2, v2 clamp
 s_waitcnt lgkmcnt(8)
 v_mfma_f32_32x32x16_bf16 v[80:95], v[32:35], v[168:171], v[80:95]
 ds_read_b64_tr_b16 v[32:33], v16 offset:128
 ds_read_b64_tr_b16 v[34:35], v16 offset:288
 v_max_f32 v64, s62, v64
 v_exp_f32 v3, v3 clamp
 v_max_f32 v65, s62, v65
 v_mfma_f32_32x32x16_bf16 v[80:95], v[36:39], v[172:175], v[80:95]
 ds_read_b64_tr_b16 v[36:37], v16 offset:2688
 ds_read_b64_tr_b16 v[38:39], v16 offset:2848
 v_exp_f32 v4, v4 clamp
 v_max_f32 v66, s62, v66
 v_exp_f32 v5, v5 clamp
 s_waitcnt lgkmcnt(8)
 v_mfma_f32_32x32x16_bf16 v[80:95], v[40:43], v[176:179], v[80:95]
 ds_read_b64_tr_b16 v[40:41], v16 offset:5248
 ds_read_b64_tr_b16 v[42:43], v16 offset:5408
 v_max_f32 v67, s62, v67
 v_exp_f32 v6, v6 clamp
 v_max_f32 v68, s62, v68
 v_mfma_f32_32x32x16_bf16 v[80:95], v[44:47], v[180:183], v[80:95]
 ds_read_b64_tr_b16 v[44:45], v16 offset:7808
 ds_read_b64_tr_b16 v[46:47], v16 offset:7968
 v_exp_f32 v7, v7 clamp
 v_max_f32 v69, s62, v69
 v_exp_f32 v8, v8 clamp
 s_waitcnt lgkmcnt(8)
 v_mfma_f32_32x32x16_bf16 v[80:95], v[24:27], v[184:187], v[80:95]
 ds_read_b64_tr_b16 v[24:25], v16 offset:10368
 ds_read_b64_tr_b16 v[26:27], v16 offset:10528
 v_max_f32 v70, s62, v70
 v_exp_f32 v9, v9 clamp
 v_max_f32 v71, s62, v71
 v_mfma_f32_32x32x16_bf16 v[80:95], v[28:31], v[188:191], v[80:95]
 ds_read_b64_tr_b16 v[28:29], v16 offset:12928
 ds_read_b64_tr_b16 v[30:31], v16 offset:13088
 v_add_f32 v64, v64, v2
 v_add_f32 v65, v65, v3
 v_add_f32 v66, v66, v4
 s_waitcnt lgkmcnt(8)
 v_mfma_f32_32x32x16_bf16 v[80:95], v[32:35], v[192:195], v[80:95]
 ds_read_b64_tr_b16 v[32:33], v16 offset:15488
 ds_read_b64_tr_b16 v[34:35], v16 offset:15648
 v_add_f32 v67, v67, v5
 v_add_f32 v68, v68, v6
 v_add_f32 v69, v69, v7
 v_mfma_f32_32x32x16_bf16 v[80:95], v[36:39], v[196:199], v[80:95]
 ds_read_b64_tr_b16 v[36:37], v16 offset:18048
 ds_read_b64_tr_b16 v[38:39], v16 offset:18208
 v_add_f32 v70, v70, v8
 v_add_f32 v71, v71, v9
 v_mul_f32 v2, s60, v72
 s_waitcnt lgkmcnt(8)
 v_mfma_f32_32x32x16_bf16 v[80:95], v[40:43], v[200:203], v[80:95]
 ds_read_b64_tr_b16 v[40:41], v16 offset:20608
 ds_read_b64_tr_b16 v[42:43], v16 offset:20768
 v_mul_f32 v3, s60, v73
 v_mul_f32 v4, s60, v74
 v_mul_f32 v5, s60, v75
 v_mfma_f32_32x32x16_bf16 v[80:95], v[44:47], v[204:207], v[80:95]
 ds_read_b64_tr_b16 v[44:45], v16 offset:23168
 ds_read_b64_tr_b16 v[46:47], v16 offset:23328
 v_mul_f32 v6, s60, v76
 v_mul_f32 v7, s60, v77
 v_mul_f32 v8, s60, v78
 s_waitcnt lgkmcnt(8)
 v_mfma_f32_32x32x16_bf16 v[80:95], v[24:27], v[208:211], v[80:95]
 ds_read_b64_tr_b16 v[24:25], v16 offset:25728
 ds_read_b64_tr_b16 v[26:27], v16 offset:25888
 v_mul_f32 v9, s60, v79
 v_exp_f32 v2, v2 clamp
 v_max_f32 v72, s62, v72
 v_mfma_f32_32x32x16_bf16 v[80:95], v[28:31], v[212:215], v[80:95]
 ds_read_b64_tr_b16 v[28:29], v16 offset:28288
 ds_read_b64_tr_b16 v[30:31], v16 offset:28448
 v_exp_f32 v3, v3 clamp
 v_max_f32 v73, s62, v73
 v_exp_f32 v4, v4 clamp
 s_waitcnt lgkmcnt(8)
 v_mfma_f32_32x32x16_bf16 v[80:95], v[32:35], v[216:219], v[80:95]
 ds_read_b64_tr_b16 v[32:33], v16 offset:30848
 ds_read_b64_tr_b16 v[34:35], v16 offset:31008
 v_max_f32 v74, s62, v74
 v_exp_f32 v5, v5 clamp
 v_max_f32 v75, s62, v75
 v_mfma_f32_32x32x16_bf16 v[80:95], v[36:39], v[220:223], v[80:95]
 ds_read_b64_tr_b16 v[36:37], v16 offset:33408
 ds_read_b64_tr_b16 v[38:39], v16 offset:33568
 v_exp_f32 v6, v6 clamp
 v_max_f32 v76, s62, v76
 v_exp_f32 v7, v7 clamp
 s_waitcnt lgkmcnt(8)
 v_mfma_f32_32x32x16_bf16 v[80:95], v[40:43], v[224:227], v[80:95]
 ds_read_b64_tr_b16 v[40:41], v16 offset:35968
 ds_read_b64_tr_b16 v[42:43], v16 offset:36128
 v_max_f32 v77, s62, v77
 v_exp_f32 v8, v8 clamp
 v_max_f32 v78, s62, v78
 v_mfma_f32_32x32x16_bf16 v[80:95], v[44:47], v[228:231], v[80:95]
 ds_read_b64_tr_b16 v[44:45], v16 offset:38528
 ds_read_b64_tr_b16 v[46:47], v16 offset:38688
 v_exp_f32 v9, v9 clamp
 v_max_f32 v79, s62, v79
 v_add_f32 v72, v72, v2
 s_waitcnt lgkmcnt(10)
 v_mfma_f32_32x32x16_bf16 v[80:95], v[24:27], v[232:235], v[80:95]
 v_add_f32 v73, v73, v3
 v_add_f32 v74, v74, v4
 v_add_f32 v75, v75, v5
 s_waitcnt lgkmcnt(8)
 v_mfma_f32_32x32x16_bf16 v[80:95], v[28:31], v[236:239], v[80:95]
 v_add_f32 v76, v76, v6
 v_add_f32 v77, v77, v7
 v_add_f32 v78, v78, v8
 s_waitcnt lgkmcnt(6)
 v_mfma_f32_32x32x16_bf16 v[80:95], v[32:35], v[240:243], v[80:95]
 v_add_f32 v79, v79, v9
 v_cvt_pk_bf16_f32 v104, v64, v65
 v_cvt_pk_bf16_f32 v105, v66, v67
 s_waitcnt lgkmcnt(4)
 v_mfma_f32_32x32x16_bf16 v[80:95], v[36:39], v[244:247], v[80:95]
 v_cvt_pk_bf16_f32 v106, v68, v69
 v_cvt_pk_bf16_f32 v107, v70, v71
 v_cvt_pk_bf16_f32 v108, v72, v73
 s_waitcnt lgkmcnt(2)
 v_mfma_f32_32x32x16_bf16 v[80:95], v[40:43], v[248:251], v[80:95]
 v_cvt_pk_bf16_f32 v109, v74, v75
 v_cvt_pk_bf16_f32 v110, v76, v77
 v_cvt_pk_bf16_f32 v111, v78, v79
 s_waitcnt lgkmcnt(0)
 v_mfma_f32_32x32x16_bf16 v[80:95], v[44:47], v[252:255], v[80:95]
 s_nop 11
 v_mul_f32 v2, s60, v80
 v_mul_f32 v3, s60, v81
 v_mul_f32 v4, s60, v82
 v_mul_f32 v5, s60, v83
 v_mul_f32 v6, s60, v84
 v_mul_f32 v7, s60, v85
 v_mul_f32 v8, s60, v86
 v_mul_f32 v9, s60, v87
 v_exp_f32 v2, v2 clamp
 v_max_f32 v80, s62, v80
 v_exp_f32 v3, v3 clamp
 v_max_f32 v81, s62, v81
 v_exp_f32 v4, v4 clamp
 v_max_f32 v82, s62, v82
 v_exp_f32 v5, v5 clamp
 v_max_f32 v83, s62, v83
 v_exp_f32 v6, v6 clamp
 v_max_f32 v84, s62, v84
 v_exp_f32 v7, v7 clamp
 v_max_f32 v85, s62, v85
 v_exp_f32 v8, v8 clamp
 v_max_f32 v86, s62, v86
 v_exp_f32 v9, v9 clamp
 v_max_f32 v87, s62, v87
 v_add_f32 v80, v80, v2
 v_add_f32 v81, v81, v3
 v_add_f32 v82, v82, v4
 v_add_f32 v83, v83, v5
 v_add_f32 v84, v84, v6
 v_add_f32 v85, v85, v7
 v_add_f32 v86, v86, v8
 v_add_f32 v87, v87, v9
 v_cvt_pk_bf16_f32 v112, v80, v81
 v_cvt_pk_bf16_f32 v113, v82, v83
 v_cvt_pk_bf16_f32 v114, v84, v85
 v_cvt_pk_bf16_f32 v115, v86, v87
 v_lshlrev_b32 v2, 4, v1
 v_add_u32 v3, 147456, v2
 s_lshl_b32 s9, s22, 2
 s_add_u32 s9, s9, s8
 s_mul_i32 s63, s9, 40960
 s_mul_i32 s60, s23, 5120
 s_add_u32 s63, s63, s60
 s_add_u32 s63, s63, 1572864
 s_add_u32 s10, s63, 4096
 v_cmp_gt_u32 vcc, 32, v1
 s_barrier
 ds_read_b128 v[192:195], v3 offset:7168
 ds_read_b128 v[196:199], v3 offset:8192
 ds_read_b128 v[200:203], v3 offset:9216
 ds_read_b128 v[204:207], v3 offset:10240
 ds_read_b128 v[208:211], v3 offset:11264
 ds_read_b128 v[164:167], v3 offset:0
 ds_read_b128 v[168:171], v3 offset:1024
 ds_read_b128 v[172:175], v3 offset:2048
 ds_read_b128 v[176:179], v3 offset:3072
 ds_read_b128 v[180:183], v3 offset:4096
 ds_read_b128 v[184:187], v3 offset:5120
 ds_read_b128 v[188:191], v3 offset:6144
 s_waitcnt lgkmcnt(11)
 v_mfma_f32_32x32x16_bf16 v[148:163], v[192:195], v[96:99], 0
 s_waitcnt lgkmcnt(10)
 v_mfma_f32_32x32x16_bf16 v[148:163], v[196:199], v[100:103], v[148:163]
 s_waitcnt lgkmcnt(9)
 v_mfma_f32_32x32x16_bf16 v[148:163], v[200:203], v[104:107], v[148:163]
 s_waitcnt lgkmcnt(8)
 v_mfma_f32_32x32x16_bf16 v[148:163], v[204:207], v[108:111], v[148:163]
 s_waitcnt lgkmcnt(7)
 v_mfma_f32_32x32x16_bf16 v[148:163], v[208:211], v[112:115], v[148:163]
 s_waitcnt lgkmcnt(6)
 v_mfma_f32_32x32x16_bf16 v[116:131], v[164:167], v[96:99], 0
 s_waitcnt lgkmcnt(5)
 v_mfma_f32_32x32x16_bf16 v[116:131], v[168:171], v[100:103], v[116:131]
 s_waitcnt lgkmcnt(4)
 v_mfma_f32_32x32x16_bf16 v[116:131], v[172:175], v[104:107], v[116:131]
 s_nop 5
 v_add_f32 v156, s62, v156
 v_add_f32 v157, s62, v157
 v_add_f32 v158, s62, v158
 v_add_f32 v159, s62, v159
 s_waitcnt lgkmcnt(3)
 v_mfma_f32_32x32x16_bf16 v[132:147], v[176:179], v[100:103], 0
 v_rcp_f32 v156, v156
 v_rcp_f32 v157, v157
 v_rcp_f32 v158, v158
 v_rcp_f32 v159, v159
 s_waitcnt lgkmcnt(2)
 v_mfma_f32_32x32x16_bf16 v[132:147], v[180:183], v[104:107], v[132:147]
 v_cndmask_b32 v160, v157, v156, vcc
 v_cndmask_b32 v161, v159, v158, vcc
 v_mul_f32 v148, v148, v159
 v_mul_f32 v149, v149, v159
 v_mul_f32 v150, v150, v159
 v_mul_f32 v151, v151, v159
 v_mul_f32 v152, v152, v159
 v_mul_f32 v153, v153, v159
 v_mul_f32 v154, v154, v159
 v_mul_f32 v155, v155, v159
 v_cvt_pk_bf16_f32 v228, v148, v149
 v_cvt_pk_bf16_f32 v229, v150, v151
 v_cvt_pk_bf16_f32 v230, v152, v153
 v_cvt_pk_bf16_f32 v231, v154, v155
 v_max_u32 v228, 1, v228
 buffer_store_dwordx4 v[228:231], v2, s[80:83], s10 offen offset:0 sc1
 s_waitcnt lgkmcnt(1)
 v_mfma_f32_32x32x16_bf16 v[132:147], v[184:187], v[108:111], v[132:147]
 v_mul_f32 v116, v116, v156
 v_mul_f32 v117, v117, v156
 v_mul_f32 v118, v118, v156
 v_mul_f32 v119, v119, v156
 v_mul_f32 v120, v120, v156
 v_mul_f32 v121, v121, v156
 v_mul_f32 v122, v122, v156
 v_mul_f32 v123, v123, v156
 v_cvt_pk_bf16_f32 v212, v116, v117
 v_cvt_pk_bf16_f32 v213, v118, v119
 v_cvt_pk_bf16_f32 v214, v120, v121
 v_cvt_pk_bf16_f32 v215, v122, v123
 v_max_u32 v212, 1, v212
 buffer_store_dwordx4 v[212:215], v2, s[80:83], s63 offen offset:0 sc1
 s_waitcnt lgkmcnt(0)
 v_mfma_f32_32x32x16_bf16 v[132:147], v[188:191], v[112:115], v[132:147]
 v_mul_f32 v124, v124, v160
 v_mul_f32 v125, v125, v160
 v_mul_f32 v126, v126, v160
 v_mul_f32 v127, v127, v160
 v_mul_f32 v128, v128, v157
 v_mul_f32 v129, v129, v157
 v_mul_f32 v130, v130, v157
 v_mul_f32 v131, v131, v157
 v_cvt_pk_bf16_f32 v216, v124, v125
 v_cvt_pk_bf16_f32 v217, v126, v127
 v_cvt_pk_bf16_f32 v218, v128, v129
 v_cvt_pk_bf16_f32 v219, v130, v131
 v_max_u32 v216, 1, v216
 buffer_store_dwordx4 v[216:219], v2, s[80:83], s63 offen offset:1024 sc1
 v_mul_f32 v132, v132, v157
 v_mul_f32 v133, v133, v157
 v_mul_f32 v134, v134, v157
 v_mul_f32 v135, v135, v157
 v_mul_f32 v136, v136, v158
 v_mul_f32 v137, v137, v158
 v_mul_f32 v138, v138, v158
 v_mul_f32 v139, v139, v158
 v_cvt_pk_bf16_f32 v220, v132, v133
 v_cvt_pk_bf16_f32 v221, v134, v135
 v_cvt_pk_bf16_f32 v222, v136, v137
 v_cvt_pk_bf16_f32 v223, v138, v139
 v_max_u32 v220, 1, v220
 buffer_store_dwordx4 v[220:223], v2, s[80:83], s63 offen offset:2048 sc1
 v_mul_f32 v140, v140, v158
 v_mul_f32 v141, v141, v158
 v_mul_f32 v142, v142, v158
 v_mul_f32 v143, v143, v158
 v_mul_f32 v144, v144, v161
 v_mul_f32 v145, v145, v161
 v_mul_f32 v146, v146, v161
 v_mul_f32 v147, v147, v161
 v_cvt_pk_bf16_f32 v224, v140, v141
 v_cvt_pk_bf16_f32 v225, v142, v143
 v_cvt_pk_bf16_f32 v226, v144, v145
 v_cvt_pk_bf16_f32 v227, v146, v147
 v_max_u32 v224, 1, v224
 buffer_store_dwordx4 v[224:227], v2, s[80:83], s63 offen offset:3072 sc1
 s_barrier
 s_branch LB_done
LB_compute:
 s_lshr_b32 s22, s24, 1
 s_lshl_b32 s22, s22, 2
 s_lshr_b32 s26, s25, 2
 s_add_u32 s22, s22, s26
 s_and_b32 s23, s24, 1
 s_mul_i32 s27, s23, 5
 s_lshl_b32 s23, s23, 2
 s_and_b32 s28, s25, 3
 s_add_u32 s27, s27, s28
 s_add_u32 s23, s23, s28
 v_and_b32 v1, 63, v0
 s_and_b32 s8, s20, 3
 v_and_b32 v14, 15, v1
 v_lshrrev_b32 v15, 4, v1
 v_mul_u32_u24 v28, 2560, v15
 v_lshl_add_u32 v28, v14, 4, v28
 v_lshrrev_b32 v10, 1, v14
 v_xor_b32 v10, v10, v15
 s_and_b32 s60, s22, 3
 v_xor_b32 v10, s60, v10
 v_lshlrev_b32 v14, 7, v14
 v_lshl_add_u32 v2, v10, 4, v14
 s_lshl_b32 s60, s8, 12
 v_add_u32 v2, s60, v2
 v_xor_b32 v3, 64, v2
 v_lshrrev_b32 v14, 2, v1
 v_mul_u32_u24 v14, 160, v14
 v_and_b32 v15, 3, v1
 v_lshl_add_u32 v10, v15, 3, v14
 v_mov_b32 v6, v2
 v_mov_b32 v7, v3
 v_add_u32 v12, 65536, v10
 s_mov_b32 s12, 0
 s_mov_b32 s13, 65536
 s_mov_b32 s14, 0
 s_mov_b32 s61, 0x358637bd
 v_mov_b32 v64, s61
 v_mov_b32 v65, s61
 v_mov_b32 v66, s61
 v_mov_b32 v67, s61
 v_mov_b32 v68, s61
 v_mov_b32 v69, s61
 v_mov_b32 v70, s61
 v_mov_b32 v71, s61
 v_mov_b32 v72, s61
 v_mov_b32 v73, s61
 v_mov_b32 v74, s61
 v_mov_b32 v75, s61
 v_mov_b32 v76, s61
 v_mov_b32 v77, s61
 v_mov_b32 v78, s61
 v_mov_b32 v79, s61
 v_mov_b32 v80, s61
 v_mov_b32 v81, s61
 v_mov_b32 v82, s61
 v_mov_b32 v83, s61
 v_mov_b32 v84, s61
 v_mov_b32 v85, s61
 v_mov_b32 v86, s61
 v_mov_b32 v87, s61
 v_mov_b32 v88, s61
 v_mov_b32 v89, s61
 v_mov_b32 v90, s61
 v_mov_b32 v91, s61
 v_mov_b32 v92, s61
 v_mov_b32 v93, s61
 v_mov_b32 v94, s61
 v_mov_b32 v95, s61
 v_mov_b32 v96, s61
 v_mov_b32 v97, s61
 v_mov_b32 v98, s61
 v_mov_b32 v99, s61
 v_mov_b32 v100, s61
 v_mov_b32 v101, s61
 v_mov_b32 v102, s61
 v_mov_b32 v103, s61
 v_mov_b32 v104, 0
 v_mov_b32 v105, 0
 v_mov_b32 v106, 0
 v_mov_b32 v107, 0
 v_mov_b32 v108, 0
 v_mov_b32 v109, 0
 v_mov_b32 v110, 0
 v_mov_b32 v111, 0
 v_mov_b32 v112, 0
 v_mov_b32 v113, 0
 v_mov_b32 v114, 0
 v_mov_b32 v115, 0
 v_mov_b32 v116, 0
 v_mov_b32 v117, 0
 v_mov_b32 v118, 0
 v_mov_b32 v119, 0
 v_mov_b32 v120, 0
 v_mov_b32 v121, 0
 v_mov_b32 v122, 0
 v_mov_b32 v123, 0
 v_mov_b32 v124, 0
 v_mov_b32 v125, 0
 v_mov_b32 v126, 0
 v_mov_b32 v127, 0
 v_mov_b32 v128, 0
 v_mov_b32 v129, 0
 v_mov_b32 v130, 0
 v_mov_b32 v131, 0
 v_mov_b32 v132, 0
 v_mov_b32 v133, 0
 v_mov_b32 v134, 0
 v_mov_b32 v135, 0
 v_mov_b32 v136, 0
 v_mov_b32 v137, 0
 v_mov_b32 v138, 0
 v_mov_b32 v139, 0
 v_mov_b32 v140, 0
 v_mov_b32 v141, 0
 v_mov_b32 v142, 0
 v_mov_b32 v143, 0
 v_lshlrev_b32 v140, 4, v0
 v_add_u32 v140, 147456, v140
 ds_write_b128 v140, v[112:115]
 ds_write_b128 v140, v[112:115] offset:4096
 ds_write_b128 v140, v[112:115] offset:8192
 ds_write_b128 v140, v[112:115] offset:12288
 v_mov_b32 v140, 0
 v_and_b32 v40, 31, v1
 v_lshrrev_b32 v41, 5, v1
 v_mul_u32_u24 v42, 2560, v41
 v_lshl_add_u32 v42, v40, 4, v42
 s_mul_i32 s60, s8, 320
 s_add_u32 s60, s60, 65536
 v_add_u32 v16, s60, v42
 s_mul_i32 s60, s8, 10240
 s_add_u32 s60, s60, 65536
 v_add_u32 v28, s60, v28
 s_lshl_b32 s61, s8, 10
 s_add_u32 s61, s61, 159744
 v_mul_u32_u24 v42, 5, v40
 v_add_lshl_u32 v42, v42, v41, 3
 v_lshlrev_b32 v24, 4, v1
 v_mov_b32 v25, 0
 v_add_u32 v17, s61, v42
 v_add_u32 v19, s61, v24
 v_lshl_add_u32 v18, v40, 1, v41
 v_and_b32 v26, 15, v1
 v_lshlrev_b32 v26, 10, v26
 s_lshl_b32 s60, s23, 2
 s_add_u32 s60, s60, s8
 s_lshl_b32 s15, s60, 14
 s_add_u32 s15, s15, 1048576
 s_mul_i32 s62, s8, 20
 s_mul_i32 s63, s8, 5
 s_add_u32 s61, s61, 896
 s_add_u32 s60, s8, 80
 v_add_u32 v40, 0, v18
 v_mul_u32_u24 v41, 13108, v40
 v_lshrrev_b32 v41, 16, v41
 v_mul_u32_u24 v42, 5, v41
 v_sub_u32 v42, v40, v42
 v_add_u32 v42, s63, v42
 v_add_u32 v43, s62, v41
 v_cmp_eq_u32 vcc, 20, v41
 v_mov_b32 v47, s60
 v_mov_b32 v46, 0x720
 v_cndmask_b32 v43, v43, v47, vcc
 v_lshrrev_b32 v44, 5, v43
 v_lshlrev_b32 v44, 2, v44
 v_bfe_u32 v44, v46, v44, 4
 v_lshrrev_b32 v45, 2, v42
 v_add_u32 v44, v44, v45
 v_and_b32 v43, 31, v43
 v_and_b32 v45, 1, v42
 v_lshl_add_u32 v43, v45, 5, v43
 v_bfe_u32 v45, v42, 1, 1
 v_lshl_add_u32 v43, v43, 1, v45
 v_lshlrev_b32 v43, 3, v43
 v_lshl_add_u32 v43, v44, 10, v43
 v_add_u32 v43, 147456, v43
 v_mov_b32 v47, s61
 v_cndmask_b32 v22, v47, v43, vcc
 v_cmp_gt_u32 vcc, 21, v41
 s_nop 1
 v_cndmask_b32 v20, v47, v43, vcc
 v_add_u32 v40, 64, v18
 v_mul_u32_u24 v41, 13108, v40
 v_lshrrev_b32 v41, 16, v41
 v_mul_u32_u24 v42, 5, v41
 v_sub_u32 v42, v40, v42
 v_add_u32 v42, s63, v42
 v_add_u32 v43, s62, v41
 v_cmp_eq_u32 vcc, 20, v41
 v_mov_b32 v47, s60
 v_mov_b32 v46, 0x720
 v_cndmask_b32 v43, v43, v47, vcc
 v_lshrrev_b32 v44, 5, v43
 v_lshlrev_b32 v44, 2, v44
 v_bfe_u32 v44, v46, v44, 4
 v_lshrrev_b32 v45, 2, v42
 v_add_u32 v44, v44, v45
 v_and_b32 v43, 31, v43
 v_and_b32 v45, 1, v42
 v_lshl_add_u32 v43, v45, 5, v43
 v_bfe_u32 v45, v42, 1, 1
 v_lshl_add_u32 v43, v43, 1, v45
 v_lshlrev_b32 v43, 3, v43
 v_lshl_add_u32 v43, v44, 10, v43
 v_add_u32 v43, 147456, v43
 v_mov_b32 v47, s61
 v_cndmask_b32 v23, v47, v43, vcc
 v_cmp_gt_u32 vcc, 21, v41
 s_nop 1
 v_cndmask_b32 v21, v47, v43, vcc
 s_mov_b32 s60, 0x3f803f80
 v_mov_b32 v32, s60
 v_mov_b32 v33, s60
 v_mov_b32 v34, s60
 v_mov_b32 v35, s60
 v_mov_b32 v36, s60
 v_mov_b32 v37, s60
 v_mov_b32 v38, s60
 v_mov_b32 v39, s60
 v_mov_b32 v40, s60
 v_mov_b32 v41, s60
 v_mov_b32 v42, s60
 v_mov_b32 v43, s60
 v_mov_b32 v44, s60
 v_mov_b32 v45, s60
 v_mov_b32 v46, s60
 v_mov_b32 v47, s60
 v_mov_b32 v48, s60
 v_mov_b32 v49, s60
 v_mov_b32 v50, s60
 v_mov_b32 v51, s60
 v_mov_b32 v52, s60
 v_mov_b32 v53, s60
 v_mov_b32 v54, s60
 v_mov_b32 v55, s60
 v_mov_b32 v56, s60
 v_mov_b32 v57, s60
 v_mov_b32 v58, s60
 v_mov_b32 v59, s60
 v_mov_b32 v60, s60
 v_mov_b32 v61, s60
 v_mov_b32 v62, s60
 v_mov_b32 v63, s60
 s_waitcnt lgkmcnt(0)
 s_mov_b32 s76, s54
 s_mov_b32 s77, s55
 s_mov_b32 s78, 819200
 s_mov_b32 s79, 0x20000
 s_mov_b32 s80, s30
 s_mov_b32 s81, s31
 s_mov_b32 s82, 16777216
 s_mov_b32 s83, 0x20000
 s_mov_b32 s84, s58
 s_mov_b32 s85, s59
 s_mov_b32 s86, 256
 s_mov_b32 s87, 0x20000
 s_mov_b32 s4, s56
 s_mov_b32 s5, s57
 s_mov_b32 s6, 5242880
 s_mov_b32 s7, 0x20000
 v_lshrrev_b32 v30, 3, v1
 v_mul_u32_u24 v31, 1280, v30
 v_lshlrev_b32 v30, 1, v30
 v_and_b32 v30, 4, v30
 v_and_b32 v27, 7, v1
 v_xor_b32 v30, v30, v27
 v_lshl_add_u32 v27, v30, 4, v31
 s_mov_b32 s18, 0
 s_lshl_b32 s60, s8, 3
 s_add_u32 s18, s18, s60
 s_mul_i32 s18, s18, 1280
 s_lshl_b32 s60, s27, 7
 s_add_u32 s18, s18, s60
 s_lshl_b32 s19, s8, 10
 s_barrier
 ds_read_b128 v[224:227], v6 offset:0
 ds_read_b128 v[228:231], v6 offset:2048
 ds_read_b64_tr_b16 v[144:145], v12 offset:0
 ds_read_b64_tr_b16 v[146:147], v12 offset:2560
 ds_read_b64_tr_b16 v[148:149], v12 offset:32
 ds_read_b64_tr_b16 v[150:151], v12 offset:2592
 ds_read_b64_tr_b16 v[152:153], v12 offset:64
 ds_read_b64_tr_b16 v[154:155], v12 offset:2624
 ds_read_b64_tr_b16 v[156:157], v12 offset:96
 ds_read_b64_tr_b16 v[158:159], v12 offset:2656
 ds_read_b64_tr_b16 v[160:161], v12 offset:128
 ds_read_b64_tr_b16 v[162:163], v12 offset:2688
 ds_read_b64_tr_b16 v[164:165], v12 offset:10240
 ds_read_b64_tr_b16 v[166:167], v12 offset:12800
 ds_read_b64_tr_b16 v[168:169], v12 offset:10272
LB_kv_loop:
 s_waitcnt lgkmcnt(7)
 v_mfma_f32_16x16x32_bf16 v[64:67], v[224:227], v[144:147], v[64:67]
 ds_read_b64_tr_b16 v[170:171], v12 offset:12832
 v_mfma_f32_16x16x32_bf16 v[68:71], v[228:231], v[144:147], v[68:71]
 ds_read_b64_tr_b16 v[172:173], v12 offset:10304
 v_mfma_f32_16x16x32_bf16 v[72:75], v[224:227], v[148:151], v[72:75]
 ds_read_b64_tr_b16 v[174:175], v12 offset:12864
 ds_read_b128 v[232:235], v7 offset:0
 v_mfma_f32_16x16x32_bf16 v[76:79], v[228:231], v[148:151], v[76:79]
 ds_read_b128 v[236:239], v7 offset:2048
 v_mfma_f32_16x16x32_bf16 v[80:83], v[224:227], v[152:155], v[80:83]
 ds_read_b64_tr_b16 v[176:177], v12 offset:10336
 v_mfma_f32_16x16x32_bf16 v[84:87], v[228:231], v[152:155], v[84:87]
 ds_read_b64_tr_b16 v[178:179], v12 offset:12896
 s_waitcnt lgkmcnt(8)
 v_mfma_f32_16x16x32_bf16 v[88:91], v[224:227], v[156:159], v[88:91]
 ds_read_b64_tr_b16 v[180:181], v12 offset:10368
 ds_read_b64_tr_b16 v[182:183], v12 offset:12928
 v_mfma_f32_16x16x32_bf16 v[92:95], v[228:231], v[156:159], v[92:95]
 ds_read_b64_tr_b16 v[184:185], v12 offset:5120
 v_mfma_f32_16x16x32_bf16 v[96:99], v[224:227], v[160:163], v[96:99]
 ds_read_b64_tr_b16 v[186:187], v12 offset:7680
 v_mfma_f32_16x16x32_bf16 v[100:103], v[228:231], v[160:163], v[100:103]
 ds_read_b64_tr_b16 v[188:189], v12 offset:5152
 ds_read_b64_tr_b16 v[190:191], v12 offset:7712
 v_mfma_f32_16x16x32_bf16 v[104:107], v[224:227], v[164:167], v[104:107]
 ds_read_b64_tr_b16 v[192:193], v12 offset:5184
 v_mfma_f32_16x16x32_bf16 v[108:111], v[228:231], v[164:167], v[108:111]
 ds_read_b64_tr_b16 v[194:195], v12 offset:7744
 s_waitcnt lgkmcnt(8)
 v_mfma_f32_16x16x32_bf16 v[112:115], v[224:227], v[168:171], v[112:115]
 ds_read_b64_tr_b16 v[196:197], v12 offset:5216
 ds_read_b64_tr_b16 v[198:199], v12 offset:7776
 v_mfma_f32_16x16x32_bf16 v[116:119], v[228:231], v[168:171], v[116:119]
 ds_read_b64_tr_b16 v[200:201], v12 offset:5248
 v_mfma_f32_16x16x32_bf16 v[120:123], v[224:227], v[172:175], v[120:123]
 ds_read_b64_tr_b16 v[202:203], v12 offset:7808
 v_mfma_f32_16x16x32_bf16 v[124:127], v[228:231], v[172:175], v[124:127]
 ds_read_b64_tr_b16 v[204:205], v12 offset:15360
 v_mfma_f32_16x16x32_bf16 v[128:131], v[224:227], v[176:179], v[128:131]
 ds_read_b64_tr_b16 v[206:207], v12 offset:17920
 ds_read_b64_tr_b16 v[208:209], v12 offset:15392
 v_mfma_f32_16x16x32_bf16 v[132:135], v[228:231], v[176:179], v[132:135]
 ds_read_b64_tr_b16 v[210:211], v12 offset:17952
 s_waitcnt lgkmcnt(10)
 v_mfma_f32_16x16x32_bf16 v[136:139], v[224:227], v[180:183], v[136:139]
 ds_read_b64_tr_b16 v[212:213], v12 offset:15424
 v_mfma_f32_16x16x32_bf16 v[140:143], v[228:231], v[180:183], v[140:143]
 ds_read_b64_tr_b16 v[214:215], v12 offset:17984
 ds_read_b64_tr_b16 v[216:217], v12 offset:15456
 v_mfma_f32_16x16x32_bf16 v[64:67], v[232:235], v[184:187], v[64:67]
 ds_read_b64_tr_b16 v[218:219], v12 offset:18016
 v_mfma_f32_16x16x32_bf16 v[68:71], v[236:239], v[184:187], v[68:71]
 ds_read_b64_tr_b16 v[220:221], v12 offset:15488
 v_mfma_f32_16x16x32_bf16 v[72:75], v[232:235], v[188:191], v[72:75]
 ds_read_b64_tr_b16 v[222:223], v12 offset:18048
 v_mfma_f32_16x16x32_bf16 v[76:79], v[236:239], v[188:191], v[76:79]
 s_waitcnt lgkmcnt(10)
 v_mfma_f32_16x16x32_bf16 v[80:83], v[232:235], v[192:195], v[80:83]
 s_add_u32 s12, s12, 16384
 s_and_b32 s12, s12, 0xffff
 v_mfma_f32_16x16x32_bf16 v[84:87], v[236:239], v[192:195], v[84:87]
 s_add_u32 s13, s13, 20480
 s_cmp_ge_u32 s13, 147456
 s_cselect_b32 s13, 65536, s13
 v_mfma_f32_16x16x32_bf16 v[88:91], v[232:235], v[196:199], v[88:91]
 v_add_u32 v6, s12, v2
 v_add_u32 v7, s12, v3
 v_mfma_f32_16x16x32_bf16 v[92:95], v[236:239], v[196:199], v[92:95]
 v_add_u32 v12, s13, v10
 s_add_u32 s14, s14, 1
 s_cmp_lt_u32 s14, 10
 v_mfma_f32_16x16x32_bf16 v[96:99], v[232:235], v[200:203], v[96:99]
 s_waitcnt lgkmcnt(0)
 s_barrier
 v_mfma_f32_16x16x32_bf16 v[100:103], v[236:239], v[200:203], v[100:103]
 ds_read_b128 v[224:227], v6 offset:0
 ds_read_b128 v[228:231], v6 offset:2048
 v_mfma_f32_16x16x32_bf16 v[104:107], v[232:235], v[204:207], v[104:107]
 ds_read_b64_tr_b16 v[144:145], v12 offset:0
 v_mfma_f32_16x16x32_bf16 v[108:111], v[236:239], v[204:207], v[108:111]
 ds_read_b64_tr_b16 v[146:147], v12 offset:2560
 v_mfma_f32_16x16x32_bf16 v[112:115], v[232:235], v[208:211], v[112:115]
 ds_read_b64_tr_b16 v[148:149], v12 offset:32
 ds_read_b64_tr_b16 v[150:151], v12 offset:2592
 v_mfma_f32_16x16x32_bf16 v[116:119], v[236:239], v[208:211], v[116:119]
 ds_read_b64_tr_b16 v[152:153], v12 offset:64
 v_mfma_f32_16x16x32_bf16 v[120:123], v[232:235], v[212:215], v[120:123]
 ds_read_b64_tr_b16 v[154:155], v12 offset:2624
 v_mfma_f32_16x16x32_bf16 v[124:127], v[236:239], v[212:215], v[124:127]
 ds_read_b64_tr_b16 v[156:157], v12 offset:96
 ds_read_b64_tr_b16 v[158:159], v12 offset:2656
 v_mfma_f32_16x16x32_bf16 v[128:131], v[232:235], v[216:219], v[128:131]
 ds_read_b64_tr_b16 v[160:161], v12 offset:128
 v_mfma_f32_16x16x32_bf16 v[132:135], v[236:239], v[216:219], v[132:135]
 ds_read_b64_tr_b16 v[162:163], v12 offset:2688
 v_mfma_f32_16x16x32_bf16 v[136:139], v[232:235], v[220:223], v[136:139]
 ds_read_b64_tr_b16 v[164:165], v12 offset:10240
 v_mfma_f32_16x16x32_bf16 v[140:143], v[236:239], v[220:223], v[140:143]
 ds_read_b64_tr_b16 v[166:167], v12 offset:12800
 ds_read_b64_tr_b16 v[168:169], v12 offset:10272
 s_cbranch_scc1 LB_kv_loop
 buffer_load_dword v29, v25, s[84:87], 0 offen sc1
 s_setprio 3
 s_mov_b32 s60, 0x3fb8aa3b
 s_mov_b32 s62, 0x358637bd
 v_mul_f32 v240, s60, v64
 v_mul_f32 v241, s60, v65
 v_mul_f32 v242, s60, v66
 v_mul_f32 v243, s60, v67
 v_mul_f32 v244, s60, v68
 v_mul_f32 v245, s60, v69
 v_mul_f32 v246, s60, v70
 v_mul_f32 v247, s60, v71
 v_exp_f32 v240, v240 clamp
 v_exp_f32 v241, v241 clamp
 v_exp_f32 v242, v242 clamp
 v_exp_f32 v243, v243 clamp
 v_exp_f32 v244, v244 clamp
 v_exp_f32 v245, v245 clamp
 v_exp_f32 v246, v246 clamp
 v_exp_f32 v247, v247 clamp
 v_max_f32 v64, s62, v64
 v_max_f32 v65, s62, v65
 v_max_f32 v66, s62, v66
 v_max_f32 v67, s62, v67
 v_max_f32 v68, s62, v68
 v_max_f32 v69, s62, v69
 v_max_f32 v70, s62, v70
 v_max_f32 v71, s62, v71
 v_add_f32 v64, v64, v240
 v_add_f32 v65, v65, v241
 v_add_f32 v66, v66, v242
 v_add_f32 v67, v67, v243
 v_add_f32 v68, v68, v244
 v_add_f32 v69, v69, v245
 v_add_f32 v70, v70, v246
 v_add_f32 v71, v71, v247
 v_cvt_pk_bf16_f32 v104, v104, v105
 v_cvt_pk_bf16_f32 v105, v106, v107
 v_cvt_pk_bf16_f32 v106, v108, v109
 v_cvt_pk_bf16_f32 v107, v110, v111
 ds_write_b128 v28, v[104:107] offset:1280
 v_mul_f32 v248, s60, v72
 v_mul_f32 v249, s60, v73
 v_mul_f32 v250, s60, v74
 v_mul_f32 v251, s60, v75
 v_mul_f32 v252, s60, v76
 v_mul_f32 v253, s60, v77
 v_mul_f32 v254, s60, v78
 v_mul_f32 v255, s60, v79
 v_cvt_pk_bf16_f32 v64, v64, v65
 v_exp_f32 v248, v248 clamp
 v_exp_f32 v249, v249 clamp
 v_exp_f32 v250, v250 clamp
 v_exp_f32 v251, v251 clamp
 v_exp_f32 v252, v252 clamp
 v_exp_f32 v253, v253 clamp
 v_exp_f32 v254, v254 clamp
 v_exp_f32 v255, v255 clamp
 v_cvt_pk_bf16_f32 v65, v66, v67
 v_max_f32 v72, s62, v72
 v_max_f32 v73, s62, v73
 v_max_f32 v74, s62, v74
 v_max_f32 v75, s62, v75
 v_max_f32 v76, s62, v76
 v_max_f32 v77, s62, v77
 v_max_f32 v78, s62, v78
 v_max_f32 v79, s62, v79
 v_cvt_pk_bf16_f32 v66, v68, v69
 v_cvt_pk_bf16_f32 v67, v70, v71
 v_add_f32 v72, v72, v248
 v_add_f32 v73, v73, v249
 v_add_f32 v74, v74, v250
 v_add_f32 v75, v75, v251
 v_add_f32 v76, v76, v252
 v_add_f32 v77, v77, v253
 v_add_f32 v78, v78, v254
 v_add_f32 v79, v79, v255
 ds_write_b128 v28, v[64:67] offset:0
 v_cvt_pk_bf16_f32 v112, v112, v113
 v_cvt_pk_bf16_f32 v113, v114, v115
 v_cvt_pk_bf16_f32 v114, v116, v117
 v_cvt_pk_bf16_f32 v115, v118, v119
 ds_write_b128 v28, v[112:115] offset:1536
 v_mul_f32 v240, s60, v80
 v_mul_f32 v241, s60, v81
 v_mul_f32 v242, s60, v82
 v_mul_f32 v243, s60, v83
 v_mul_f32 v244, s60, v84
 v_mul_f32 v245, s60, v85
 v_mul_f32 v246, s60, v86
 v_mul_f32 v247, s60, v87
 v_cvt_pk_bf16_f32 v72, v72, v73
 v_exp_f32 v240, v240 clamp
 v_exp_f32 v241, v241 clamp
 v_exp_f32 v242, v242 clamp
 v_exp_f32 v243, v243 clamp
 v_exp_f32 v244, v244 clamp
 v_exp_f32 v245, v245 clamp
 v_exp_f32 v246, v246 clamp
 v_exp_f32 v247, v247 clamp
 v_cvt_pk_bf16_f32 v73, v74, v75
 v_max_f32 v80, s62, v80
 v_max_f32 v81, s62, v81
 v_max_f32 v82, s62, v82
 v_max_f32 v83, s62, v83
 v_max_f32 v84, s62, v84
 v_max_f32 v85, s62, v85
 v_max_f32 v86, s62, v86
 v_max_f32 v87, s62, v87
 v_cvt_pk_bf16_f32 v74, v76, v77
 v_cvt_pk_bf16_f32 v75, v78, v79
 v_add_f32 v80, v80, v240
 v_add_f32 v81, v81, v241
 v_add_f32 v82, v82, v242
 v_add_f32 v83, v83, v243
 v_add_f32 v84, v84, v244
 v_add_f32 v85, v85, v245
 v_add_f32 v86, v86, v246
 v_add_f32 v87, v87, v247
 ds_write_b128 v28, v[72:75] offset:256
 v_cvt_pk_bf16_f32 v120, v120, v121
 v_cvt_pk_bf16_f32 v121, v122, v123
 v_cvt_pk_bf16_f32 v122, v124, v125
 v_cvt_pk_bf16_f32 v123, v126, v127
 ds_write_b128 v28, v[120:123] offset:1792
 v_mul_f32 v248, s60, v88
 v_mul_f32 v249, s60, v89
 v_mul_f32 v250, s60, v90
 v_mul_f32 v251, s60, v91
 v_mul_f32 v252, s60, v92
 v_mul_f32 v253, s60, v93
 v_mul_f32 v254, s60, v94
 v_mul_f32 v255, s60, v95
 v_cvt_pk_bf16_f32 v80, v80, v81
 v_exp_f32 v248, v248 clamp
 v_exp_f32 v249, v249 clamp
 v_exp_f32 v250, v250 clamp
 v_exp_f32 v251, v251 clamp
 v_exp_f32 v252, v252 clamp
 v_exp_f32 v253, v253 clamp
 v_exp_f32 v254, v254 clamp
 v_exp_f32 v255, v255 clamp
 v_cvt_pk_bf16_f32 v81, v82, v83
 v_max_f32 v88, s62, v88
 v_max_f32 v89, s62, v89
 v_max_f32 v90, s62, v90
 v_max_f32 v91, s62, v91
 v_max_f32 v92, s62, v92
 v_max_f32 v93, s62, v93
 v_max_f32 v94, s62, v94
 v_max_f32 v95, s62, v95
 v_cvt_pk_bf16_f32 v82, v84, v85
 v_cvt_pk_bf16_f32 v83, v86, v87
 v_add_f32 v88, v88, v248
 v_add_f32 v89, v89, v249
 v_add_f32 v90, v90, v250
 v_add_f32 v91, v91, v251
 v_add_f32 v92, v92, v252
 v_add_f32 v93, v93, v253
 v_add_f32 v94, v94, v254
 v_add_f32 v95, v95, v255
 ds_write_b128 v28, v[80:83] offset:512
 v_cvt_pk_bf16_f32 v128, v128, v129
 v_cvt_pk_bf16_f32 v129, v130, v131
 v_cvt_pk_bf16_f32 v130, v132, v133
 v_cvt_pk_bf16_f32 v131, v134, v135
 ds_write_b128 v28, v[128:131] offset:2048
 v_mul_f32 v240, s60, v96
 v_mul_f32 v241, s60, v97
 v_mul_f32 v242, s60, v98
 v_mul_f32 v243, s60, v99
 v_mul_f32 v244, s60, v100
 v_mul_f32 v245, s60, v101
 v_mul_f32 v246, s60, v102
 v_mul_f32 v247, s60, v103
 v_cvt_pk_bf16_f32 v88, v88, v89
 v_exp_f32 v240, v240 clamp
 v_exp_f32 v241, v241 clamp
 v_exp_f32 v242, v242 clamp
 v_exp_f32 v243, v243 clamp
 v_exp_f32 v244, v244 clamp
 v_exp_f32 v245, v245 clamp
 v_exp_f32 v246, v246 clamp
 v_exp_f32 v247, v247 clamp
 v_cvt_pk_bf16_f32 v89, v90, v91
 v_max_f32 v96, s62, v96
 v_max_f32 v97, s62, v97
 v_max_f32 v98, s62, v98
 v_max_f32 v99, s62, v99
 v_max_f32 v100, s62, v100
 v_max_f32 v101, s62, v101
 v_max_f32 v102, s62, v102
 v_max_f32 v103, s62, v103
 v_cvt_pk_bf16_f32 v90, v92, v93
 v_cvt_pk_bf16_f32 v91, v94, v95
 v_add_f32 v96, v96, v240
 v_add_f32 v97, v97, v241
 v_add_f32 v98, v98, v242
 v_add_f32 v99, v99, v243
 v_add_f32 v100, v100, v244
 v_add_f32 v101, v101, v245
 v_add_f32 v102, v102, v246
 v_add_f32 v103, v103, v247
 ds_write_b128 v28, v[88:91] offset:768
 v_cvt_pk_bf16_f32 v136, v136, v137
 v_cvt_pk_bf16_f32 v137, v138, v139
 v_cvt_pk_bf16_f32 v138, v140, v141
 v_cvt_pk_bf16_f32 v139, v142, v143
 ds_write_b128 v28, v[136:139] offset:2304
 v_cvt_pk_bf16_f32 v96, v96, v97
 v_cvt_pk_bf16_f32 v97, v98, v99
 v_cvt_pk_bf16_f32 v98, v100, v101
 v_cvt_pk_bf16_f32 v99, v102, v103
 ds_write_b128 v28, v[96:99] offset:1024
 s_waitcnt lgkmcnt(0)
 v_mov_b32 v192, 160760
 v_mov_b32 v193, 1
 s_mov_b64 exec, 1
 ds_add_u32 v192, v193
 s_mov_b64 exec, -1
LB_cs:
 ds_read_b32 v193, v192
 s_waitcnt lgkmcnt(0)
 v_readfirstlane_b32 s60, v193
 s_nop 0
 s_cmp_lt_u32 s60, 4
 s_cbranch_scc1 LB_cs
 ds_read_b128 v[64:67], v16 offset:0
 s_mov_b32 exec_lo, 0xffefffff
 s_mov_b32 exec_hi, 0xffefffff
 ds_read_b128 v[32:35], v16 offset:1280
 s_mov_b64 exec, -1
 ds_read_b128 v[68:71], v16 offset:5120
 s_mov_b32 exec_lo, 0xffefffff
 s_mov_b32 exec_hi, 0xffefffff
 ds_read_b128 v[36:39], v16 offset:6400
 s_mov_b64 exec, -1
 ds_read_b128 v[72:75], v16 offset:10240
 s_mov_b32 exec_lo, 0xffefffff
 s_mov_b32 exec_hi, 0xffefffff
 ds_read_b128 v[40:43], v16 offset:11520
 s_mov_b64 exec, -1
 ds_read_b128 v[76:79], v16 offset:15360
 s_mov_b32 exec_lo, 0xffefffff
 s_mov_b32 exec_hi, 0xffefffff
 ds_read_b128 v[44:47], v16 offset:16640
 s_mov_b64 exec, -1
 ds_read_b128 v[80:83], v16 offset:20480
 s_mov_b32 exec_lo, 0xffefffff
 s_mov_b32 exec_hi, 0xffefffff
 ds_read_b128 v[48:51], v16 offset:21760
 s_mov_b64 exec, -1
 ds_read_b128 v[84:87], v16 offset:25600
 s_mov_b32 exec_lo, 0xffefffff
 s_mov_b32 exec_hi, 0xffefffff
 ds_read_b128 v[52:55], v16 offset:26880
 s_mov_b64 exec, -1
 ds_read_b128 v[88:91], v16 offset:30720
 s_mov_b32 exec_lo, 0xffefffff
 s_mov_b32 exec_hi, 0xffefffff
 ds_read_b128 v[56:59], v16 offset:32000
 s_mov_b64 exec, -1
 ds_read_b128 v[92:95], v16 offset:35840
 s_mov_b32 exec_lo, 0xffefffff
 s_mov_b32 exec_hi, 0xffefffff
 ds_read_b128 v[60:63], v16 offset:37120
 s_mov_b64 exec, -1
 s_waitcnt lgkmcnt(14)
 v_mfma_f32_32x32x16_bf16 v[96:111], v[64:67], v[32:35], 0
 s_waitcnt lgkmcnt(12)
 v_mfma_f32_32x32x16_bf16 v[96:111], v[68:71], v[36:39], v[96:111]
 s_waitcnt lgkmcnt(10)
 v_mfma_f32_32x32x16_bf16 v[96:111], v[72:75], v[40:43], v[96:111]
 s_waitcnt lgkmcnt(8)
 v_mfma_f32_32x32x16_bf16 v[96:111], v[76:79], v[44:47], v[96:111]
 s_waitcnt lgkmcnt(6)
 v_mfma_f32_32x32x16_bf16 v[96:111], v[80:83], v[48:51], v[96:111]
 s_waitcnt lgkmcnt(4)
 v_mfma_f32_32x32x16_bf16 v[96:111], v[84:87], v[52:55], v[96:111]
 s_waitcnt lgkmcnt(2)
 v_mfma_f32_32x32x16_bf16 v[96:111], v[88:91], v[56:59], v[96:111]
 s_waitcnt lgkmcnt(0)
 v_mfma_f32_32x32x16_bf16 v[96:111], v[92:95], v[60:63], v[96:111]
 v_mov_b32 v193, 1
 s_mov_b64 exec, 1
 ds_add_u32 v192, v193
 s_mov_b64 exec, -1
 s_mov_b32 s61, 0
LB_init:
 s_waitcnt vmcnt(0)
 v_readfirstlane_b32 s62, v29
 s_nop 0
 s_cmp_eq_u32 s62, 1
 s_cbranch_scc1 LB_initd
 s_sleep 8
 buffer_load_dword v29, v25, s[84:87], 0 offen offset:0 sc1
 s_add_u32 s61, s61, 1
 s_cmp_lt_u32 s61, 65536
 s_cbranch_scc1 LB_init
LB_initd:
 s_lshl_b32 s60, s22, 10
 s_add_u32 s60, s60, s15
 v_cvt_pk_bf16_f32 v44, v96, v97
 v_cvt_pk_bf16_f32 v45, v98, v99
 v_cvt_pk_bf16_f32 v46, v100, v101
 v_cvt_pk_bf16_f32 v47, v102, v103
 v_cvt_pk_bf16_f32 v48, v104, v105
 v_cvt_pk_bf16_f32 v49, v106, v107
 s_mov_b32 exec_lo, 0x1fffff
 s_mov_b32 exec_hi, 0x1fffff
 ds_write_b64 v17, v[44:45]
 ds_write_b64 v17, v[46:47] offset:16
 s_mov_b32 exec_hi, 0
 ds_write_b64 v17, v[48:49] offset:32
 s_mov_b64 exec, -1
 ds_read_b128 v[44:47], v19
 s_waitcnt lgkmcnt(0)
 v_max_u32 v44, 1, v44
 buffer_store_dwordx4 v[44:47], v24, s[80:83], s60 offen sc1
 s_setprio 0
LB_cs2:
 ds_read_b32 v193, v192
 s_waitcnt lgkmcnt(0)
 v_readfirstlane_b32 s60, v193
 s_nop 0
 s_cmp_lt_u32 s60, 8
 s_cbranch_scc1 LB_cs2
 s_add_u32 s62, s19, 65536
 s_mov_b32 s14, 0
LB_wo1:
 s_mov_b32 m0, s62
 s_add_u32 s60, s18, 40960
 buffer_load_dwordx4 v27, s[76:79], s18 offen lds
 s_cmp_ge_u32 s60, 819200
 s_cselect_b32 s18, 819200, 0
 s_sub_u32 s18, s60, s18
 s_add_u32 s62, s62, 4096
 s_add_u32 s14, s14, 1
 s_cmp_lt_u32 s14, 10
 s_cbranch_scc1 LB_wo1
 v_and_b32 v50, 31, v1
 v_lshrrev_b32 v51, 5, v1
 v_lshlrev_b32 v51, 3, v51
 v_sub_u32 v50, v50, v51
 v_mov_b32 v52, 0x3f80
 v_and_b32 v53, 1, v50
 v_lshlrev_b32 v53, 4, v53
 v_lshlrev_b32 v52, v53, v52
 v_lshrrev_b32 v50, 1, v50
 v_cmp_eq_u32 vcc, 0, v50
 s_nop 1
 v_cndmask_b32 v60, 0, v52, vcc
 v_cmp_eq_u32 vcc, 1, v50
 s_nop 1
 v_cndmask_b32 v61, 0, v52, vcc
 v_cmp_eq_u32 vcc, 2, v50
 s_nop 1
 v_cndmask_b32 v62, 0, v52, vcc
 v_cmp_eq_u32 vcc, 3, v50
 s_nop 1
 v_cndmask_b32 v63, 0, v52, vcc
 s_mov_b32 s61, 0
 s_mov_b32 s63, 0
LB_poll1:
 buffer_load_dword v44, v26, s[80:83], s15 offen offset:1008 sc1
 s_add_u32 s60, s15, 0
 buffer_load_dwordx4 v[64:67], v24, s[80:83], s60 offen offset:0 sc1
 buffer_load_dwordx4 v[68:71], v24, s[80:83], s60 offen offset:1024 sc1
 buffer_load_dwordx4 v[72:75], v24, s[80:83], s60 offen offset:2048 sc1
 buffer_load_dwordx4 v[76:79], v24, s[80:83], s60 offen offset:3072 sc1
 s_add_u32 s60, s15, 4096
 buffer_load_dwordx4 v[80:83], v24, s[80:83], s60 offen offset:0 sc1
 buffer_load_dwordx4 v[84:87], v24, s[80:83], s60 offen offset:1024 sc1
 buffer_load_dwordx4 v[88:91], v24, s[80:83], s60 offen offset:2048 sc1
 buffer_load_dwordx4 v[92:95], v24, s[80:83], s60 offen offset:3072 sc1
 s_add_u32 s60, s15, 8192
 buffer_load_dwordx4 v[96:99], v24, s[80:83], s60 offen offset:0 sc1
 buffer_load_dwordx4 v[100:103], v24, s[80:83], s60 offen offset:1024 sc1
 buffer_load_dwordx4 v[104:107], v24, s[80:83], s60 offen offset:2048 sc1
 buffer_load_dwordx4 v[108:111], v24, s[80:83], s60 offen offset:3072 sc1
 s_add_u32 s60, s15, 12288
 buffer_load_dwordx4 v[112:115], v24, s[80:83], s60 offen offset:0 sc1
 buffer_load_dwordx4 v[116:119], v24, s[80:83], s60 offen offset:1024 sc1
 buffer_load_dwordx4 v[120:123], v24, s[80:83], s60 offen offset:2048 sc1
 buffer_load_dwordx4 v[124:127], v24, s[80:83], s60 offen offset:3072 sc1
 buffer_load_dword v29, v25, s[84:87], 0 offen offset:4 sc1
 s_waitcnt vmcnt(17)
 v_cmp_eq_u32 vcc, 0, v44
 s_add_u32 s61, s61, 1
 s_cmp_ge_u32 s61, 65536
 s_cbranch_scc1 LB_poll1d
 s_cbranch_vccnz LB_poll1
LB_poll1d:
 s_waitcnt vmcnt(16)
 v_mfma_f32_32x32x16_bf16 v[128:143], v[60:63], v[64:67], 0
 s_waitcnt vmcnt(15)
 v_mfma_f32_32x32x16_bf16 v[128:143], v[60:63], v[68:71], v[128:143]
 v_min3_u32 v44, v44, v64, v68
 s_waitcnt vmcnt(14)
 v_mfma_f32_32x32x16_bf16 v[128:143], v[60:63], v[72:75], v[128:143]
 s_waitcnt vmcnt(13)
 v_mfma_f32_32x32x16_bf16 v[128:143], v[60:63], v[76:79], v[128:143]
 v_min3_u32 v44, v44, v72, v76
 s_waitcnt vmcnt(12)
 v_mfma_f32_32x32x16_bf16 v[128:143], v[60:63], v[80:83], v[128:143]
 s_waitcnt vmcnt(11)
 v_mfma_f32_32x32x16_bf16 v[128:143], v[60:63], v[84:87], v[128:143]
 v_min3_u32 v44, v44, v80, v84
 s_waitcnt vmcnt(10)
 v_mfma_f32_32x32x16_bf16 v[128:143], v[60:63], v[88:91], v[128:143]
 s_waitcnt vmcnt(9)
 v_mfma_f32_32x32x16_bf16 v[128:143], v[60:63], v[92:95], v[128:143]
 v_min3_u32 v44, v44, v88, v92
 s_waitcnt vmcnt(8)
 v_mfma_f32_32x32x16_bf16 v[128:143], v[60:63], v[96:99], v[128:143]
 s_waitcnt vmcnt(7)
 v_mfma_f32_32x32x16_bf16 v[128:143], v[60:63], v[100:103], v[128:143]
 v_min3_u32 v44, v44, v96, v100
 s_waitcnt vmcnt(6)
 v_mfma_f32_32x32x16_bf16 v[128:143], v[60:63], v[104:107], v[128:143]
 s_waitcnt vmcnt(5)
 v_mfma_f32_32x32x16_bf16 v[128:143], v[60:63], v[108:111], v[128:143]
 v_min3_u32 v44, v44, v104, v108
 s_waitcnt vmcnt(4)
 v_mfma_f32_32x32x16_bf16 v[128:143], v[60:63], v[112:115], v[128:143]
 s_waitcnt vmcnt(3)
 v_mfma_f32_32x32x16_bf16 v[128:143], v[60:63], v[116:119], v[128:143]
 v_min3_u32 v44, v44, v112, v116
 s_waitcnt vmcnt(2)
 v_mfma_f32_32x32x16_bf16 v[128:143], v[60:63], v[120:123], v[128:143]
 s_waitcnt vmcnt(1)
 v_mfma_f32_32x32x16_bf16 v[128:143], v[60:63], v[124:127], v[128:143]
 v_min3_u32 v44, v44, v120, v124
 v_cmp_eq_u32 vcc, 0, v44
 s_cmp_ge_u32 s61, 65536
 s_nop 7
 s_cbranch_scc1 LB_sumok
 s_nop 6
 s_cbranch_vccz LB_sumok

 s_branch LB_poll1
LB_sumok:
 v_cvt_pk_bf16_f32 v44, v128, v129
 v_cvt_pk_bf16_f32 v45, v130, v131
 v_cvt_pk_bf16_f32 v46, v132, v133
 v_cvt_pk_bf16_f32 v47, v134, v135
 ds_write_b64 v20, v[44:45]
 ds_write_b64 v22, v[44:45] offset:64
 ds_write_b64 v21, v[46:47]
 ds_write_b64 v23, v[46:47] offset:64
 s_mov_b32 s61, 0
LB_init2:
 s_waitcnt vmcnt(0)
 v_readfirstlane_b32 s62, v29
 s_nop 0
 s_cmp_eq_u32 s62, 1
 s_cbranch_scc1 LB_init2d
 s_sleep 8
 buffer_load_dword v29, v25, s[84:87], 0 offen offset:4 sc1
 s_add_u32 s61, s61, 1
 s_cmp_lt_u32 s61, 65536
 s_cbranch_scc1 LB_init2
LB_init2d:
 s_waitcnt lgkmcnt(0)
 s_barrier
 s_mov_b32 s65, 0
 s_branch LB_out2
LB_out_entry:
 s_and_b32 s8, s20, 3
 v_mov_b32 v25, 0
 v_mov_b32 v29, 0
 s_mov_b32 s76, s54
 s_mov_b32 s77, s55
 s_mov_b32 s78, 819200
 s_mov_b32 s79, 0x20000
 s_mov_b32 s80, s30
 s_mov_b32 s81, s31
 s_mov_b32 s82, 16777216
 s_mov_b32 s83, 0x20000
 s_mov_b32 s84, s58
 s_mov_b32 s85, s59
 s_mov_b32 s86, 256
 s_mov_b32 s87, 0x20000
 s_mov_b32 s4, s56
 s_mov_b32 s5, s57
 s_mov_b32 s6, 5242880
 s_mov_b32 s7, 0x20000
 v_lshrrev_b32 v30, 3, v1
 v_mul_u32_u24 v31, 1280, v30
 v_lshlrev_b32 v30, 1, v30
 v_and_b32 v30, 4, v30
 v_and_b32 v27, 7, v1
 v_xor_b32 v30, v30, v27
 v_lshl_add_u32 v27, v30, 4, v31
 s_mov_b32 s18, 0
 s_lshl_b32 s60, s8, 3
 s_add_u32 s18, s18, s60
 s_mul_i32 s18, s18, 1280
 s_lshl_b32 s60, s27, 7
 s_add_u32 s18, s18, s60
 s_lshl_b32 s19, s8, 10
 s_add_u32 s62, s19, 65536
 s_mov_b32 s14, 0
LB_wo1h:
 s_mov_b32 m0, s62
 s_add_u32 s60, s18, 40960
 buffer_load_dwordx4 v27, s[76:79], s18 offen lds
 s_cmp_ge_u32 s60, 819200
 s_cselect_b32 s18, 819200, 0
 s_sub_u32 s18, s60, s18
 s_add_u32 s62, s62, 4096
 s_add_u32 s14, s14, 1
 s_cmp_lt_u32 s14, 10
 s_cbranch_scc1 LB_wo1h
 s_mov_b32 s61, 0
LB_hinit:
 s_waitcnt vmcnt(0)
 v_readfirstlane_b32 s62, v29
 s_nop 0
 s_cmp_eq_u32 s62, 1
 s_cbranch_scc1 LB_hinitd
 s_sleep 8
 buffer_load_dword v29, v25, s[84:87], 0 offen offset:4 sc1
 s_add_u32 s61, s61, 1
 s_cmp_lt_u32 s61, 65536
 s_cbranch_scc1 LB_hinit
LB_hinitd:
 s_barrier
 s_mov_b32 s65, 1
LB_out2:
 s_add_u32 s62, s19, 106496
 s_mov_b32 s14, 0
LB_wo2c:
 s_mov_b32 m0, s62
 s_add_u32 s60, s18, 40960
 buffer_load_dwordx4 v27, s[76:79], s18 offen lds
 s_cmp_ge_u32 s60, 819200
 s_cselect_b32 s18, 819200, 0
 s_sub_u32 s18, s60, s18
 s_add_u32 s62, s62, 4096
 s_add_u32 s14, s14, 1
 s_cmp_lt_u32 s14, 10
 s_cbranch_scc1 LB_wo2c
 v_lshlrev_b32 v2, 4, v1
 v_add_u32 v14, 4096, v2
 v_bfe_u32 v3, v1, 2, 2
 v_lshrrev_b32 v4, 5, v1
 v_lshl_add_u32 v4, v4, 2, v3
 v_lshlrev_b32 v4, 7, v4
 v_lshlrev_b32 v3, 5, v3
 v_and_b32 v3, 64, v3
 v_and_b32 v5, 1, v1
 v_lshl_add_u32 v3, v5, 5, v3
 v_and_b32 v5, 16, v1
 v_add_u32 v3, v3, v5
 v_and_b32 v5, 2, v1
 v_lshl_add_u32 v3, v5, 2, v3
 v_add_u32 v8, v3, v4
 s_lshl_b32 s62, s22, 2
 s_add_u32 s62, s62, s8
 s_mul_i32 s62, s62, 40960
 s_add_u32 s62, s62, 1572864
 s_lshl_b32 s60, s62, 1
 s_sub_u32 s60, 65536, s60
 v_add_u32 v8, s60, v8
 v_xor_b32 v9, 64, v8
 s_mul_i32 s17, s28, 13
 s_lshr_b32 s17, s17, 3
 v_add_u32 v6, s17, v1
 v_and_b32 v6, 7, v6
 v_mul_u32_u24 v6, 5120, v6
 v_add_u32 v6, 4096, v6
 v_lshrrev_b32 v7, 3, v1
 v_mul_u32_u24 v12, 2560, v7
 v_and_b32 v5, 7, v1
 v_lshl_add_u32 v12, v5, 4, v12
 v_xor_b32 v3, v5, v7
 v_lshlrev_b32 v7, 7, v7
 v_lshl_add_u32 v15, v3, 4, v7
 s_lshl_b32 s61, s8, 12
 v_add_u32 v15, s61, v15
 v_lshrrev_b32 v3, 4, v1
 v_and_b32 v3, 2, v3
 v_xor_b32 v3, v3, v5
 v_and_b32 v4, 31, v1
 v_lshlrev_b32 v4, 7, v4
 v_lshl_add_u32 v10, v3, 4, v4
 v_add_u32 v10, s61, v10
 v_xor_b32 v11, 16, v10
 v_xor_b32 v4, 64, v10
 v_xor_b32 v5, 0x50, v10
 s_lshl_b32 s19, s22, 7
 s_lshl_b32 s61, s8, 5
 s_add_u32 s19, s19, s61
 s_mul_i32 s19, s19, 2560
 s_lshl_b32 s61, s27, 7
 s_add_u32 s19, s19, s61
 s_add_u32 s19, s19, 1280
 s_mov_b32 s64, 8
 s_waitcnt vmcnt(0)
 s_barrier
LB_hwd:
 s_mov_b32 s61, 0
LB_out_retry:
 v_mov_b32 v13, -1
 s_mov_b32 s18, 0xff
 s_mov_b32 s63, 0
LB_pick:
 s_waitcnt lgkmcnt(0)
 s_ff1_i32_b32 s60, s18
 s_bitset0_b32 s18, s60
 s_add_u32 s60, s60, s17
 s_and_b32 s60, s60, 7
 s_mul_i32 s60, s60, 5120
 s_add_u32 s9, s60, s62
 v_lshl_add_u32 v80, s9, 1, v8
 v_lshl_add_u32 v81, s9, 1, v9
 ds_read_b64_tr_b16 v[48:49], v80 offset:8192
 ds_read_b64_tr_b16 v[50:51], v80 offset:9216
 ds_read_b64_tr_b16 v[52:53], v81 offset:8192
 ds_read_b64_tr_b16 v[54:55], v81 offset:9216
 s_ff1_i32_b32 s60, s18
 s_bitset0_b32 s18, s60
 s_add_u32 s60, s60, s17
 s_and_b32 s60, s60, 7
 s_mul_i32 s60, s60, 5120
 s_add_u32 s10, s60, s62
 v_lshl_add_u32 v82, s10, 1, v8
 v_lshl_add_u32 v83, s10, 1, v9
 ds_read_b64_tr_b16 v[56:57], v82 offset:8192
 ds_read_b64_tr_b16 v[58:59], v82 offset:9216
 ds_read_b64_tr_b16 v[60:61], v83 offset:8192
 ds_read_b64_tr_b16 v[62:63], v83 offset:9216
 s_ff1_i32_b32 s60, s18
 s_bitset0_b32 s18, s60
 s_add_u32 s60, s60, s17
 s_and_b32 s60, s60, 7
 s_mul_i32 s60, s60, 5120
 s_add_u32 s11, s60, s62
 v_lshl_add_u32 v84, s11, 1, v8
 v_lshl_add_u32 v85, s11, 1, v9
 ds_read_b64_tr_b16 v[64:65], v84 offset:8192
 ds_read_b64_tr_b16 v[66:67], v84 offset:9216
 ds_read_b64_tr_b16 v[68:69], v85 offset:8192
 ds_read_b64_tr_b16 v[70:71], v85 offset:9216
 s_ff1_i32_b32 s60, s18
 s_bitset0_b32 s18, s60
 s_add_u32 s60, s60, s17
 s_and_b32 s60, s60, 7
 s_mul_i32 s60, s60, 5120
 s_add_u32 s12, s60, s62
 v_lshl_add_u32 v86, s12, 1, v8
 v_lshl_add_u32 v87, s12, 1, v9
 s_ff1_i32_b32 s60, s18
 s_bitset0_b32 s18, s60
 s_add_u32 s60, s60, s17
 s_and_b32 s60, s60, 7
 s_mul_i32 s60, s60, 5120
 s_add_u32 s13, s60, s62
 v_lshl_add_u32 v88, s13, 1, v8
 v_lshl_add_u32 v89, s13, 1, v9
 s_ff1_i32_b32 s60, s18
 s_bitset0_b32 s18, s60
 s_add_u32 s60, s60, s17
 s_and_b32 s60, s60, 7
 s_mul_i32 s60, s60, 5120
 s_add_u32 s14, s60, s62
 v_lshl_add_u32 v90, s14, 1, v8
 v_lshl_add_u32 v91, s14, 1, v9
 s_ff1_i32_b32 s60, s18
 s_bitset0_b32 s18, s60
 s_mov_b32 s66, s60
 s_add_u32 s60, s60, s17
 s_and_b32 s60, s60, 7
 s_mul_i32 s60, s60, 5120
 s_add_u32 s15, s60, s62
 v_lshl_add_u32 v92, s15, 1, v8
 v_lshl_add_u32 v93, s15, 1, v9
 s_ff1_i32_b32 s60, s18
 s_bitset0_b32 s18, s60
 s_mov_b32 s67, s60
 s_add_u32 s60, s60, s17
 s_and_b32 s60, s60, 7
 s_mul_i32 s60, s60, 5120
 s_add_u32 s16, s60, s62
 v_lshl_add_u32 v94, s16, 1, v8
 v_lshl_add_u32 v95, s16, 1, v9
 s_cmp_lg_u32 s63, 0
 s_cbranch_scc1 LB_go

LB_poll2:
 buffer_load_dword v7, v6, s[80:83], s62 offen offset:1008 sc1
 s_waitcnt vmcnt(0)
 v_cmp_ne_u32 vcc, 0, v7
 s_add_u32 s61, s61, 1
 s_cmp_ge_u32 s61, 65536
 s_cbranch_scc1 LB_go
 s_and_b32 s18, vcc_lo, 0xff
 s_cmp_eq_u32 s18, 0xff
 s_cbranch_scc1 LB_go
 s_bcnt1_i32_b32 s60, s18
 s_cmp_ge_u32 s60, s64
 s_cbranch_scc1 LB_poll2d
 s_sleep 2
 s_cmp_eq_u32 s65, 0
 s_cbranch_scc1 LB_poll2
 s_sleep 4
 s_branch LB_poll2
LB_poll2d:
 s_xor_b32 s60, s18, 0xff
 s_lshl_b32 s60, s60, 8
 s_or_b32 s18, s18, s60
 s_mov_b32 s63, 1
 s_branch LB_pick
LB_go:
 buffer_load_dwordx4 v[96:99], v14, s[80:83], s9 offen offset:0 sc1
 buffer_load_dwordx4 v[100:103], v14, s[80:83], s10 offen offset:0 sc1
 buffer_load_dwordx4 v[104:107], v14, s[80:83], s11 offen offset:0 sc1
 buffer_load_dwordx4 v[108:111], v14, s[80:83], s12 offen offset:0 sc1
 buffer_load_dwordx4 v[112:115], v14, s[80:83], s13 offen offset:0 sc1
 buffer_load_dwordx4 v[116:119], v14, s[80:83], s14 offen offset:0 sc1
 buffer_load_dwordx4 v[120:123], v14, s[80:83], s15 offen offset:0 sc1
 buffer_load_dwordx4 v[124:127], v14, s[80:83], s16 offen offset:0 sc1
 buffer_load_dwordx4 v[128:131], v2, s[80:83], s9 offen offset:0 sc1
 buffer_load_dwordx4 v[132:135], v2, s[80:83], s10 offen offset:0 sc1
 s_waitcnt vmcnt(9) lgkmcnt(8)
 v_mfma_f32_32x32x16_bf16 v[16:31], v[48:51], v[96:99], 0
 ds_read_b64_tr_b16 v[72:73], v86 offset:8192
 ds_read_b64_tr_b16 v[74:75], v86 offset:9216
 v_mfma_f32_32x32x16_bf16 v[32:47], v[52:55], v[96:99], 0
 ds_read_b64_tr_b16 v[76:77], v87 offset:8192
 ds_read_b64_tr_b16 v[78:79], v87 offset:9216
 buffer_load_dwordx4 v[136:139], v2, s[80:83], s11 offen offset:0 sc1
 s_waitcnt vmcnt(9) lgkmcnt(8)
 v_mfma_f32_32x32x16_bf16 v[16:31], v[56:59], v[100:103], v[16:31]
 ds_read_b64_tr_b16 v[48:49], v88 offset:8192
 ds_read_b64_tr_b16 v[50:51], v88 offset:9216
 v_mfma_f32_32x32x16_bf16 v[32:47], v[60:63], v[100:103], v[32:47]
 ds_read_b64_tr_b16 v[52:53], v89 offset:8192
 ds_read_b64_tr_b16 v[54:55], v89 offset:9216
 buffer_load_dwordx4 v[140:143], v2, s[80:83], s12 offen offset:0 sc1
 v_min3_u32 v13, v13, v96, v100
 s_waitcnt vmcnt(9) lgkmcnt(8)
 v_mfma_f32_32x32x16_bf16 v[16:31], v[64:67], v[104:107], v[16:31]
 ds_read_b64_tr_b16 v[56:57], v90 offset:8192
 ds_read_b64_tr_b16 v[58:59], v90 offset:9216
 v_mfma_f32_32x32x16_bf16 v[32:47], v[68:71], v[104:107], v[32:47]
 ds_read_b64_tr_b16 v[60:61], v91 offset:8192
 ds_read_b64_tr_b16 v[62:63], v91 offset:9216
 buffer_load_dwordx4 v[144:147], v2, s[80:83], s13 offen offset:0 sc1
 s_waitcnt vmcnt(9) lgkmcnt(8)
 v_mfma_f32_32x32x16_bf16 v[16:31], v[72:75], v[108:111], v[16:31]
 ds_read_b64_tr_b16 v[64:65], v92 offset:8192
 ds_read_b64_tr_b16 v[66:67], v92 offset:9216
 v_mfma_f32_32x32x16_bf16 v[32:47], v[76:79], v[108:111], v[32:47]
 ds_read_b64_tr_b16 v[68:69], v93 offset:8192
 ds_read_b64_tr_b16 v[70:71], v93 offset:9216
 buffer_load_dwordx4 v[148:151], v2, s[80:83], s14 offen offset:0 sc1
 v_min3_u32 v13, v13, v104, v108
 s_waitcnt vmcnt(9) lgkmcnt(8)
 v_mfma_f32_32x32x16_bf16 v[16:31], v[48:51], v[112:115], v[16:31]
 ds_read_b64_tr_b16 v[72:73], v94 offset:8192
 ds_read_b64_tr_b16 v[74:75], v94 offset:9216
 v_mfma_f32_32x32x16_bf16 v[32:47], v[52:55], v[112:115], v[32:47]
 ds_read_b64_tr_b16 v[76:77], v95 offset:8192
 ds_read_b64_tr_b16 v[78:79], v95 offset:9216
 buffer_load_dwordx4 v[152:155], v2, s[80:83], s15 offen offset:0 sc1
 s_waitcnt vmcnt(9) lgkmcnt(8)
 v_mfma_f32_32x32x16_bf16 v[16:31], v[56:59], v[116:119], v[16:31]
 ds_read_b64_tr_b16 v[48:49], v80 offset:0
 ds_read_b64_tr_b16 v[50:51], v80 offset:1024
 v_mfma_f32_32x32x16_bf16 v[32:47], v[60:63], v[116:119], v[32:47]
 ds_read_b64_tr_b16 v[52:53], v81 offset:0
 ds_read_b64_tr_b16 v[54:55], v81 offset:1024
 buffer_load_dwordx4 v[156:159], v2, s[80:83], s16 offen offset:0 sc1
 v_min3_u32 v13, v13, v112, v116
 s_waitcnt vmcnt(9) lgkmcnt(8)
 v_mfma_f32_32x32x16_bf16 v[16:31], v[64:67], v[120:123], v[16:31]
 ds_read_b64_tr_b16 v[56:57], v82 offset:0
 ds_read_b64_tr_b16 v[58:59], v82 offset:1024
 v_mfma_f32_32x32x16_bf16 v[32:47], v[68:71], v[120:123], v[32:47]
 ds_read_b64_tr_b16 v[60:61], v83 offset:0
 ds_read_b64_tr_b16 v[62:63], v83 offset:1024
 buffer_load_dwordx4 v[160:163], v2, s[80:83], s9 offen offset:1024 sc1
 s_waitcnt vmcnt(9) lgkmcnt(8)
 v_mfma_f32_32x32x16_bf16 v[16:31], v[72:75], v[124:127], v[16:31]
 ds_read_b64_tr_b16 v[64:65], v84 offset:0
 ds_read_b64_tr_b16 v[66:67], v84 offset:1024
 v_mfma_f32_32x32x16_bf16 v[32:47], v[76:79], v[124:127], v[32:47]
 ds_read_b64_tr_b16 v[68:69], v85 offset:0
 ds_read_b64_tr_b16 v[70:71], v85 offset:1024
 buffer_load_dwordx4 v[164:167], v2, s[80:83], s10 offen offset:1024 sc1
 v_min3_u32 v13, v13, v120, v124
 s_waitcnt vmcnt(9) lgkmcnt(8)
 v_mfma_f32_32x32x16_bf16 v[16:31], v[48:51], v[128:131], v[16:31]
 ds_read_b64_tr_b16 v[72:73], v86 offset:0
 ds_read_b64_tr_b16 v[74:75], v86 offset:1024
 v_mfma_f32_32x32x16_bf16 v[32:47], v[52:55], v[128:131], v[32:47]
 ds_read_b64_tr_b16 v[76:77], v87 offset:0
 ds_read_b64_tr_b16 v[78:79], v87 offset:1024
 buffer_load_dwordx4 v[168:171], v2, s[80:83], s11 offen offset:1024 sc1
 s_waitcnt vmcnt(9) lgkmcnt(8)
 v_mfma_f32_32x32x16_bf16 v[16:31], v[56:59], v[132:135], v[16:31]
 ds_read_b64_tr_b16 v[48:49], v88 offset:0
 ds_read_b64_tr_b16 v[50:51], v88 offset:1024
 v_mfma_f32_32x32x16_bf16 v[32:47], v[60:63], v[132:135], v[32:47]
 ds_read_b64_tr_b16 v[52:53], v89 offset:0
 ds_read_b64_tr_b16 v[54:55], v89 offset:1024
 buffer_load_dwordx4 v[172:175], v2, s[80:83], s12 offen offset:1024 sc1
 v_min3_u32 v13, v13, v128, v132
 s_waitcnt vmcnt(9) lgkmcnt(8)
 v_mfma_f32_32x32x16_bf16 v[16:31], v[64:67], v[136:139], v[16:31]
 ds_read_b64_tr_b16 v[56:57], v90 offset:0
 ds_read_b64_tr_b16 v[58:59], v90 offset:1024
 v_mfma_f32_32x32x16_bf16 v[32:47], v[68:71], v[136:139], v[32:47]
 ds_read_b64_tr_b16 v[60:61], v91 offset:0
 ds_read_b64_tr_b16 v[62:63], v91 offset:1024
 buffer_load_dwordx4 v[176:179], v2, s[80:83], s13 offen offset:1024 sc1
 s_waitcnt vmcnt(9) lgkmcnt(8)
 v_mfma_f32_32x32x16_bf16 v[16:31], v[72:75], v[140:143], v[16:31]
 ds_read_b64_tr_b16 v[64:65], v92 offset:0
 ds_read_b64_tr_b16 v[66:67], v92 offset:1024
 v_mfma_f32_32x32x16_bf16 v[32:47], v[76:79], v[140:143], v[32:47]
 ds_read_b64_tr_b16 v[68:69], v93 offset:0
 ds_read_b64_tr_b16 v[70:71], v93 offset:1024
 buffer_load_dwordx4 v[180:183], v2, s[80:83], s14 offen offset:1024 sc1
 v_min3_u32 v13, v13, v136, v140
 s_waitcnt vmcnt(9) lgkmcnt(8)
 v_mfma_f32_32x32x16_bf16 v[16:31], v[48:51], v[144:147], v[16:31]
 ds_read_b64_tr_b16 v[72:73], v94 offset:0
 ds_read_b64_tr_b16 v[74:75], v94 offset:1024
 v_mfma_f32_32x32x16_bf16 v[32:47], v[52:55], v[144:147], v[32:47]
 ds_read_b64_tr_b16 v[76:77], v95 offset:0
 ds_read_b64_tr_b16 v[78:79], v95 offset:1024
 buffer_load_dwordx4 v[184:187], v2, s[80:83], s15 offen offset:1024 sc1
 s_waitcnt vmcnt(9) lgkmcnt(8)
 v_mfma_f32_32x32x16_bf16 v[16:31], v[56:59], v[148:151], v[16:31]
 ds_read_b64_tr_b16 v[48:49], v80 offset:2048
 ds_read_b64_tr_b16 v[50:51], v80 offset:3072
 v_mfma_f32_32x32x16_bf16 v[32:47], v[60:63], v[148:151], v[32:47]
 ds_read_b64_tr_b16 v[52:53], v81 offset:2048
 ds_read_b64_tr_b16 v[54:55], v81 offset:3072
 buffer_load_dwordx4 v[188:191], v2, s[80:83], s16 offen offset:1024 sc1
 v_min3_u32 v13, v13, v144, v148
 s_waitcnt vmcnt(9) lgkmcnt(8)
 v_mfma_f32_32x32x16_bf16 v[16:31], v[64:67], v[152:155], v[16:31]
 ds_read_b64_tr_b16 v[56:57], v82 offset:2048
 ds_read_b64_tr_b16 v[58:59], v82 offset:3072
 v_mfma_f32_32x32x16_bf16 v[32:47], v[68:71], v[152:155], v[32:47]
 ds_read_b64_tr_b16 v[60:61], v83 offset:2048
 ds_read_b64_tr_b16 v[62:63], v83 offset:3072
 buffer_load_dwordx4 v[192:195], v2, s[80:83], s9 offen offset:2048 sc1
 s_waitcnt vmcnt(9) lgkmcnt(8)
 v_mfma_f32_32x32x16_bf16 v[16:31], v[72:75], v[156:159], v[16:31]
 ds_read_b64_tr_b16 v[64:65], v84 offset:2048
 ds_read_b64_tr_b16 v[66:67], v84 offset:3072
 v_mfma_f32_32x32x16_bf16 v[32:47], v[76:79], v[156:159], v[32:47]
 ds_read_b64_tr_b16 v[68:69], v85 offset:2048
 ds_read_b64_tr_b16 v[70:71], v85 offset:3072
 buffer_load_dwordx4 v[196:199], v2, s[80:83], s10 offen offset:2048 sc1
 v_min3_u32 v13, v13, v152, v156
 s_waitcnt vmcnt(9) lgkmcnt(8)
 v_mfma_f32_32x32x16_bf16 v[16:31], v[48:51], v[160:163], v[16:31]
 ds_read_b64_tr_b16 v[72:73], v86 offset:2048
 ds_read_b64_tr_b16 v[74:75], v86 offset:3072
 v_mfma_f32_32x32x16_bf16 v[32:47], v[52:55], v[160:163], v[32:47]
 ds_read_b64_tr_b16 v[76:77], v87 offset:2048
 ds_read_b64_tr_b16 v[78:79], v87 offset:3072
 buffer_load_dwordx4 v[200:203], v2, s[80:83], s11 offen offset:2048 sc1
 s_waitcnt vmcnt(9) lgkmcnt(8)
 v_mfma_f32_32x32x16_bf16 v[16:31], v[56:59], v[164:167], v[16:31]
 ds_read_b64_tr_b16 v[48:49], v88 offset:2048
 ds_read_b64_tr_b16 v[50:51], v88 offset:3072
 v_mfma_f32_32x32x16_bf16 v[32:47], v[60:63], v[164:167], v[32:47]
 ds_read_b64_tr_b16 v[52:53], v89 offset:2048
 ds_read_b64_tr_b16 v[54:55], v89 offset:3072
 buffer_load_dwordx4 v[204:207], v2, s[80:83], s12 offen offset:2048 sc1
 v_min3_u32 v13, v13, v160, v164
 s_waitcnt vmcnt(9) lgkmcnt(8)
 v_mfma_f32_32x32x16_bf16 v[16:31], v[64:67], v[168:171], v[16:31]
 ds_read_b64_tr_b16 v[56:57], v90 offset:2048
 ds_read_b64_tr_b16 v[58:59], v90 offset:3072
 v_mfma_f32_32x32x16_bf16 v[32:47], v[68:71], v[168:171], v[32:47]
 ds_read_b64_tr_b16 v[60:61], v91 offset:2048
 ds_read_b64_tr_b16 v[62:63], v91 offset:3072
 buffer_load_dwordx4 v[208:211], v2, s[80:83], s13 offen offset:2048 sc1
 s_waitcnt vmcnt(9) lgkmcnt(8)
 v_mfma_f32_32x32x16_bf16 v[16:31], v[72:75], v[172:175], v[16:31]
 ds_read_b64_tr_b16 v[64:65], v92 offset:2048
 ds_read_b64_tr_b16 v[66:67], v92 offset:3072
 v_mfma_f32_32x32x16_bf16 v[32:47], v[76:79], v[172:175], v[32:47]
 ds_read_b64_tr_b16 v[68:69], v93 offset:2048
 ds_read_b64_tr_b16 v[70:71], v93 offset:3072
 buffer_load_dwordx4 v[212:215], v2, s[80:83], s14 offen offset:2048 sc1
 v_min3_u32 v13, v13, v168, v172
 s_waitcnt vmcnt(9) lgkmcnt(8)
 v_mfma_f32_32x32x16_bf16 v[16:31], v[48:51], v[176:179], v[16:31]
 ds_read_b64_tr_b16 v[72:73], v94 offset:2048
 ds_read_b64_tr_b16 v[74:75], v94 offset:3072
 v_mfma_f32_32x32x16_bf16 v[32:47], v[52:55], v[176:179], v[32:47]
 ds_read_b64_tr_b16 v[76:77], v95 offset:2048
 ds_read_b64_tr_b16 v[78:79], v95 offset:3072
 buffer_load_dwordx4 v[216:219], v2, s[80:83], s15 offen offset:2048 sc1
 s_waitcnt vmcnt(9) lgkmcnt(8)
 v_mfma_f32_32x32x16_bf16 v[16:31], v[56:59], v[180:183], v[16:31]
 ds_read_b64_tr_b16 v[48:49], v80 offset:4096
 ds_read_b64_tr_b16 v[50:51], v80 offset:5120
 v_mfma_f32_32x32x16_bf16 v[32:47], v[60:63], v[180:183], v[32:47]
 ds_read_b64_tr_b16 v[52:53], v81 offset:4096
 ds_read_b64_tr_b16 v[54:55], v81 offset:5120
 buffer_load_dwordx4 v[220:223], v2, s[80:83], s16 offen offset:2048 sc1
 v_min3_u32 v13, v13, v176, v180
 s_waitcnt vmcnt(9) lgkmcnt(8)
 v_mfma_f32_32x32x16_bf16 v[16:31], v[64:67], v[184:187], v[16:31]
 ds_read_b64_tr_b16 v[56:57], v82 offset:4096
 ds_read_b64_tr_b16 v[58:59], v82 offset:5120
 v_mfma_f32_32x32x16_bf16 v[32:47], v[68:71], v[184:187], v[32:47]
 ds_read_b64_tr_b16 v[60:61], v83 offset:4096
 ds_read_b64_tr_b16 v[62:63], v83 offset:5120
 buffer_load_dwordx4 v[224:227], v2, s[80:83], s9 offen offset:3072 sc1
 s_waitcnt vmcnt(9) lgkmcnt(8)
 v_mfma_f32_32x32x16_bf16 v[16:31], v[72:75], v[188:191], v[16:31]
 ds_read_b64_tr_b16 v[64:65], v84 offset:4096
 ds_read_b64_tr_b16 v[66:67], v84 offset:5120
 v_mfma_f32_32x32x16_bf16 v[32:47], v[76:79], v[188:191], v[32:47]
 ds_read_b64_tr_b16 v[68:69], v85 offset:4096
 ds_read_b64_tr_b16 v[70:71], v85 offset:5120
 buffer_load_dwordx4 v[228:231], v2, s[80:83], s10 offen offset:3072 sc1
 v_min3_u32 v13, v13, v184, v188
 s_waitcnt vmcnt(9) lgkmcnt(8)
 v_mfma_f32_32x32x16_bf16 v[16:31], v[48:51], v[192:195], v[16:31]
 ds_read_b64_tr_b16 v[72:73], v86 offset:4096
 ds_read_b64_tr_b16 v[74:75], v86 offset:5120
 v_mfma_f32_32x32x16_bf16 v[32:47], v[52:55], v[192:195], v[32:47]
 ds_read_b64_tr_b16 v[76:77], v87 offset:4096
 ds_read_b64_tr_b16 v[78:79], v87 offset:5120
 buffer_load_dwordx4 v[232:235], v2, s[80:83], s11 offen offset:3072 sc1
 s_waitcnt vmcnt(9) lgkmcnt(8)
 v_mfma_f32_32x32x16_bf16 v[16:31], v[56:59], v[196:199], v[16:31]
 ds_read_b64_tr_b16 v[48:49], v88 offset:4096
 ds_read_b64_tr_b16 v[50:51], v88 offset:5120
 v_mfma_f32_32x32x16_bf16 v[32:47], v[60:63], v[196:199], v[32:47]
 ds_read_b64_tr_b16 v[52:53], v89 offset:4096
 ds_read_b64_tr_b16 v[54:55], v89 offset:5120
 buffer_load_dwordx4 v[236:239], v2, s[80:83], s12 offen offset:3072 sc1
 v_min3_u32 v13, v13, v192, v196
 s_waitcnt vmcnt(9) lgkmcnt(8)
 v_mfma_f32_32x32x16_bf16 v[16:31], v[64:67], v[200:203], v[16:31]
 ds_read_b64_tr_b16 v[56:57], v90 offset:4096
 ds_read_b64_tr_b16 v[58:59], v90 offset:5120
 v_mfma_f32_32x32x16_bf16 v[32:47], v[68:71], v[200:203], v[32:47]
 ds_read_b64_tr_b16 v[60:61], v91 offset:4096
 ds_read_b64_tr_b16 v[62:63], v91 offset:5120
 buffer_load_dwordx4 v[240:243], v2, s[80:83], s13 offen offset:3072 sc1
 s_waitcnt vmcnt(9) lgkmcnt(8)
 v_mfma_f32_32x32x16_bf16 v[16:31], v[72:75], v[204:207], v[16:31]
 ds_read_b64_tr_b16 v[64:65], v92 offset:4096
 ds_read_b64_tr_b16 v[66:67], v92 offset:5120
 v_mfma_f32_32x32x16_bf16 v[32:47], v[76:79], v[204:207], v[32:47]
 ds_read_b64_tr_b16 v[68:69], v93 offset:4096
 ds_read_b64_tr_b16 v[70:71], v93 offset:5120
 buffer_load_dwordx4 v[244:247], v2, s[80:83], s14 offen offset:3072 sc1
 v_min3_u32 v13, v13, v200, v204
 s_waitcnt vmcnt(9) lgkmcnt(8)
 v_mfma_f32_32x32x16_bf16 v[16:31], v[48:51], v[208:211], v[16:31]
 ds_read_b64_tr_b16 v[72:73], v94 offset:4096
 ds_read_b64_tr_b16 v[74:75], v94 offset:5120
 v_mfma_f32_32x32x16_bf16 v[32:47], v[52:55], v[208:211], v[32:47]
 ds_read_b64_tr_b16 v[76:77], v95 offset:4096
 ds_read_b64_tr_b16 v[78:79], v95 offset:5120
 buffer_load_dwordx4 v[248:251], v2, s[80:83], s15 offen offset:3072 sc1
 s_waitcnt vmcnt(9) lgkmcnt(8)
 v_mfma_f32_32x32x16_bf16 v[16:31], v[56:59], v[212:215], v[16:31]
 ds_read_b64_tr_b16 v[48:49], v80 offset:6144
 ds_read_b64_tr_b16 v[50:51], v80 offset:7168
 v_mfma_f32_32x32x16_bf16 v[32:47], v[60:63], v[212:215], v[32:47]
 ds_read_b64_tr_b16 v[52:53], v81 offset:6144
 ds_read_b64_tr_b16 v[54:55], v81 offset:7168
 buffer_load_dwordx4 v[252:255], v2, s[80:83], s16 offen offset:3072 sc1
 v_min3_u32 v13, v13, v208, v212
 s_waitcnt vmcnt(9) lgkmcnt(8)
 v_mfma_f32_32x32x16_bf16 v[16:31], v[64:67], v[216:219], v[16:31]
 ds_read_b64_tr_b16 v[56:57], v82 offset:6144
 ds_read_b64_tr_b16 v[58:59], v82 offset:7168
 v_mfma_f32_32x32x16_bf16 v[32:47], v[68:71], v[216:219], v[32:47]
 ds_read_b64_tr_b16 v[60:61], v83 offset:6144
 ds_read_b64_tr_b16 v[62:63], v83 offset:7168
 s_waitcnt vmcnt(8) lgkmcnt(8)
 v_mfma_f32_32x32x16_bf16 v[16:31], v[72:75], v[220:223], v[16:31]
 ds_read_b64_tr_b16 v[64:65], v84 offset:6144
 ds_read_b64_tr_b16 v[66:67], v84 offset:7168
 v_mfma_f32_32x32x16_bf16 v[32:47], v[76:79], v[220:223], v[32:47]
 ds_read_b64_tr_b16 v[68:69], v85 offset:6144
 ds_read_b64_tr_b16 v[70:71], v85 offset:7168
 v_min3_u32 v13, v13, v216, v220
 s_waitcnt vmcnt(7) lgkmcnt(8)
 v_mfma_f32_32x32x16_bf16 v[16:31], v[48:51], v[224:227], v[16:31]
 ds_read_b64_tr_b16 v[72:73], v86 offset:6144
 ds_read_b64_tr_b16 v[74:75], v86 offset:7168
 v_mfma_f32_32x32x16_bf16 v[32:47], v[52:55], v[224:227], v[32:47]
 ds_read_b64_tr_b16 v[76:77], v87 offset:6144
 ds_read_b64_tr_b16 v[78:79], v87 offset:7168
 s_waitcnt vmcnt(6) lgkmcnt(8)
 v_mfma_f32_32x32x16_bf16 v[16:31], v[56:59], v[228:231], v[16:31]
 ds_read_b64_tr_b16 v[48:49], v88 offset:6144
 ds_read_b64_tr_b16 v[50:51], v88 offset:7168
 v_mfma_f32_32x32x16_bf16 v[32:47], v[60:63], v[228:231], v[32:47]
 ds_read_b64_tr_b16 v[52:53], v89 offset:6144
 ds_read_b64_tr_b16 v[54:55], v89 offset:7168
 v_min3_u32 v13, v13, v224, v228
 s_waitcnt vmcnt(5) lgkmcnt(8)
 v_mfma_f32_32x32x16_bf16 v[16:31], v[64:67], v[232:235], v[16:31]
 ds_read_b64_tr_b16 v[56:57], v90 offset:6144
 ds_read_b64_tr_b16 v[58:59], v90 offset:7168
 v_mfma_f32_32x32x16_bf16 v[32:47], v[68:71], v[232:235], v[32:47]
 ds_read_b64_tr_b16 v[60:61], v91 offset:6144
 ds_read_b64_tr_b16 v[62:63], v91 offset:7168
 s_waitcnt vmcnt(4) lgkmcnt(8)
 v_mfma_f32_32x32x16_bf16 v[16:31], v[72:75], v[236:239], v[16:31]
 ds_read_b64_tr_b16 v[64:65], v92 offset:6144
 ds_read_b64_tr_b16 v[66:67], v92 offset:7168
 v_mfma_f32_32x32x16_bf16 v[32:47], v[76:79], v[236:239], v[32:47]
 ds_read_b64_tr_b16 v[68:69], v93 offset:6144
 ds_read_b64_tr_b16 v[70:71], v93 offset:7168
 v_min3_u32 v13, v13, v232, v236
 s_waitcnt vmcnt(3) lgkmcnt(8)
 v_mfma_f32_32x32x16_bf16 v[16:31], v[48:51], v[240:243], v[16:31]
 ds_read_b64_tr_b16 v[72:73], v94 offset:6144
 ds_read_b64_tr_b16 v[74:75], v94 offset:7168
 v_mfma_f32_32x32x16_bf16 v[32:47], v[52:55], v[240:243], v[32:47]
 ds_read_b64_tr_b16 v[76:77], v95 offset:6144
 ds_read_b64_tr_b16 v[78:79], v95 offset:7168
 s_waitcnt vmcnt(2) lgkmcnt(8)
 v_mfma_f32_32x32x16_bf16 v[16:31], v[56:59], v[244:247], v[16:31]
 v_mfma_f32_32x32x16_bf16 v[32:47], v[60:63], v[244:247], v[32:47]
 v_min3_u32 v13, v13, v240, v244
 s_waitcnt vmcnt(1) lgkmcnt(4)
 v_mfma_f32_32x32x16_bf16 v[16:31], v[64:67], v[248:251], v[16:31]
 v_mfma_f32_32x32x16_bf16 v[32:47], v[68:71], v[248:251], v[32:47]
 s_waitcnt vmcnt(0) lgkmcnt(0)
 v_mfma_f32_32x32x16_bf16 v[16:31], v[72:75], v[252:255], v[16:31]
 v_mfma_f32_32x32x16_bf16 v[32:47], v[76:79], v[252:255], v[32:47]
 v_min3_u32 v13, v13, v248, v252
 v_cmp_eq_u32 vcc, 0, v13
 s_mov_b32 s64, 8
 s_cmp_ge_u32 s61, 65536
 s_nop 5
 s_cbranch_scc1 LB_outok
 s_nop 4
 s_cbranch_vccz LB_outok

 s_branch LB_out_retry
LB_outok:
 v_cvt_pk_bf16_f32 v48, v16, v17
 v_cvt_pk_bf16_f32 v49, v18, v19
 v_cvt_pk_bf16_f32 v50, v20, v21
 v_cvt_pk_bf16_f32 v51, v22, v23
 ds_write_b128 v10, v[48:51]
 v_cvt_pk_bf16_f32 v52, v24, v25
 v_cvt_pk_bf16_f32 v53, v26, v27
 v_cvt_pk_bf16_f32 v54, v28, v29
 v_cvt_pk_bf16_f32 v55, v30, v31
 ds_write_b128 v11, v[52:55]
 v_cvt_pk_bf16_f32 v56, v32, v33
 v_cvt_pk_bf16_f32 v57, v34, v35
 v_cvt_pk_bf16_f32 v58, v36, v37
 v_cvt_pk_bf16_f32 v59, v38, v39
 ds_write_b128 v4, v[56:59]
 v_cvt_pk_bf16_f32 v60, v40, v41
 v_cvt_pk_bf16_f32 v61, v42, v43
 v_cvt_pk_bf16_f32 v62, v44, v45
 v_cvt_pk_bf16_f32 v63, v46, v47
 ds_write_b128 v5, v[60:63]
 ds_read_b128 v[64:67], v15 offset:0
 ds_read_b128 v[68:71], v15 offset:1024
 ds_read_b128 v[72:75], v15 offset:2048
 ds_read_b128 v[76:79], v15 offset:3072
 s_add_u32 s60, s19, 0
 s_waitcnt lgkmcnt(3)
 buffer_store_dwordx4 v[64:67], v12, s[4:7], s60 offen sc1
 s_add_u32 s60, s19, 20480
 s_waitcnt lgkmcnt(2)
 buffer_store_dwordx4 v[68:71], v12, s[4:7], s60 offen sc1
 s_add_u32 s60, s19, 40960
 s_waitcnt lgkmcnt(1)
 buffer_store_dwordx4 v[72:75], v12, s[4:7], s60 offen sc1
 s_add_u32 s60, s19, 61440
 s_waitcnt lgkmcnt(0)
 buffer_store_dwordx4 v[76:79], v12, s[4:7], s60 offen sc1
LB_done:
 s_branch L_fin
L_roleP:
 v_and_b32 v1, 63, v0
 s_sub_u32 s10, 32, s26
 s_mul_i32 s67, s20, s10
 s_add_u32 s67, s67, s25
 s_sub_u32 s67, s67, s26
 s_add_u32 s67, s67, 128
 s_lshl_b32 s10, s10, 3
 s_lshl_b32 s66, s20, 4
 s_add_u32 s66, s66, s25
 s_sub_u32 s66, s66, 16
 s_mov_b32 s9, 0
 v_mov_b32 v8, 0
 v_mov_b32 v9, 0
 v_mov_b32 v10, 0
 v_mov_b32 v11, 0
 v_mov_b32 v12, 1
 s_waitcnt lgkmcnt(0)

LP_loop:
 s_cmp_ge_u32 s66, 194
 s_cbranch_scc1 LP_skip
 s_and_b32 s63, s24, 1
 s_mul_i32 s63, s63, 640
 s_cmp_ge_u32 s66, 144
 s_cbranch_scc1 LPh_other
 s_mul_i32 s60, s66, 3641
 s_lshr_b32 s60, s60, 16
 s_mul_i32 s61, s60, 18
 s_sub_u32 s61, s66, s61
 s_add_u32 s60, s60, 2
 s_cmp_ge_u32 s61, 8
 s_cbranch_scc1 LPh_w
 s_lshr_b32 s62, s24, 1
 s_lshl_b32 s62, s62, 3
 s_add_u32 s62, s62, s61
 s_mul_i32 s65, s62, 81920
 s_lshl_b32 s60, s60, 7
 s_add_u32 s65, s65, s60
 s_movk_i32 s64, 1280
 s_mov_b32 s4, s50
 s_mov_b32 s5, s51
 s_mov_b32 s6, 2621440
 s_branch LPh_go
LPh_w:
 s_sub_u32 s61, s61, 8
 s_cmp_ge_u32 s61, 5
 s_cselect_b32 s62, 640, 0
 s_addk_i32 s62, 1280
 s_lshl_b32 s61, s61, 7
 s_add_u32 s65, s61, s62
 s_add_u32 s65, s65, s63
 s_mul_i32 s60, s60, 245760
 s_add_u32 s65, s65, s60
 s_movk_i32 s64, 3840
 s_mov_b32 s4, s52
 s_mov_b32 s5, s53
 s_mov_b32 s6, 2457600
 s_branch LPh_go
LPh_other:
 s_sub_u32 s60, s66, 144
 s_mul_i32 s61, s60, 13108
 s_lshr_b32 s61, s61, 16
 s_mul_i32 s62, s61, 5
 s_sub_u32 s60, s60, s62
 s_lshl_b32 s60, s60, 7
 s_mul_i32 s65, s61, 245760
 s_add_u32 s65, s65, s60
 s_add_u32 s65, s65, s63
 s_movk_i32 s64, 3840
 s_mov_b32 s4, s52
 s_mov_b32 s5, s53
 s_mov_b32 s6, 2457600
LPh_go:
 s_mov_b32 s7, 0x20000
 v_mul_u32_u24 v6, s64, v1
 buffer_load_dword v7, v6, s[4:7], s65 offen
LP_skip:
 s_cmp_lg_u32 s26, 24
 s_cbranch_scc1 LP_nz
 s_mov_b32 s62, 2
 s_mov_b32 s63, 0x100000
 s_mov_b32 s65, 0
 s_cmp_eq_u32 s9, 0
 s_cbranch_scc1 LP_z
 s_cmp_lg_u32 s9, 3
 s_cbranch_scc1 LP_nz
 s_mov_b32 s62, 10
 s_mov_b32 s63, 0x180000
 s_mov_b32 s65, 4

LP_z:
 s_sub_u32 s60, s2, 192
 s_lshr_b32 s60, s60, 1
 s_mul_i32 s60, s60, s62
 s_lshl_b32 s60, s60, 13
 s_add_u32 s60, s60, s63
 v_lshl_add_u32 v6, v0, 4, s60
 v_mov_b32 v14, s65
LP_zero:
 global_store_dwordx4 v6, v[8:11], s[30:31] sc1
 v_add_u32 v6, 8192, v6
 s_sub_u32 s62, s62, 1
 s_cmp_lg_u32 s62, 0
 s_cbranch_scc1 LP_zero
 s_waitcnt vmcnt(0)
 s_barrier
 s_cmp_lg_u32 s20, 7
 s_cbranch_scc1 LP_nz
 s_mov_b64 exec, 1
 global_atomic_add v13, v14, v12, s[58:59] offset:128 sc0
 s_waitcnt vmcnt(0)
 v_readfirstlane_b32 s60, v13
 s_nop 0
 s_cmp_lg_u32 s60, 31
 s_cbranch_scc1 LP_nl
 global_store_dword v14, v12, s[58:59] sc1
LP_nl:
 s_mov_b64 exec, -1
LP_nz:
 s_waitcnt vmcnt(0)
 s_add_u32 s9, s9, 1
 s_mov_b32 s66, s67
 s_add_u32 s67, s67, s10
 s_cmp_lt_u32 s9, 4
 s_cbranch_scc1 LP_loop
 s_cmp_lt_u32 s25, 28
 s_cbranch_scc1 L_end
 s_lshr_b32 s22, s24, 1
 s_lshl_b32 s22, s22, 2
 s_add_u32 s22, s22, s25
 s_sub_u32 s22, s22, 28
 s_mov_b32 s28, 4
 s_and_b32 s27, s24, 1
 s_mul_i32 s27, s27, 5
 s_add_u32 s27, s27, 4
 s_cmp_lt_u32 s20, 4
 s_cbranch_scc1 LB_out_entry
 s_branch L_end
L_roleA:
 s_and_b32 s26, s24, 1
 s_xor_b32 s26, s26, 0
 s_lshl_b32 s26, s26, 2
 s_sub_u32 s26, 28, s26
 s_cmp_ge_u32 s25, s26
 s_cbranch_scc1 L_roleP
 s_lshr_b32 s21, s24, 2
 s_xor_b32 s21, s21, 1
 s_and_b32 s21, s21, 1
 s_xor_b32 s21, s21, s24
 s_lshl_b32 s21, s21, 3
 s_lshl_b32 s27, s24, 1
 s_add_u32 s27, s27, 56
 s_cmp_ge_u32 s25, 24
 s_cselect_b32 s21, s27, s21
 s_add_u32 s21, s21, s25
 s_sub_u32 s21, s21, 16

 v_and_b32 v1, 63, v0
 s_lshl_b32 s10, s21, 3
 s_add_u32 s10, s10, s20
 s_mul_i32 s13, s20, 17872
 s_lshl_b32 s11, s10, 8
 v_lshl_add_u32 v29, v1, 2, s11
 s_lshl_b32 s16, s21, 4
 s_lshl_b32 s11, s10, 1
 s_and_b32 s11, s11, -4
 v_mov_b32 v37, 0
 v_mov_b32 v38, 163824
 ds_write_b32 v38, v37
 ds_write_b32 v38, v37 offset:4
 s_waitcnt lgkmcnt(0)
 global_load_dword v2, v29, s[38:39]
 global_load_dword v3, v29, s[40:41]
 global_load_dword v4, v29, s[42:43]
 global_load_dword v5, v29, s[44:45]
 s_load_dword s14, s[46:47], s11
 s_load_dword s15, s[48:49], s11
 s_mov_b32 s72, s56
 s_mov_b32 s73, s57
 s_mov_b32 s74, 5242880
 s_mov_b32 s75, 0x20000
 s_mov_b32 s68, s36
 s_mov_b32 s69, s37
 s_mov_b32 s70, 2621440
 s_mov_b32 s71, 0x20000
 s_barrier

 s_cmp_lt_u32 s20, 4
 s_cbranch_scc1 LA_old0
 s_sub_u32 s8, s20, 4
 s_lshl_b32 s8, s8, 4
 s_add_u32 s8, s8, s25
 s_sub_u32 s8, s8, 16
LA_task:
 s_and_b32 s63, s24, 1
 s_mul_i32 s63, s63, 640
 s_mul_i32 s60, s8, 3641
 s_lshr_b32 s60, s60, 16
 s_mul_i32 s61, s60, 18
 s_sub_u32 s61, s8, s61
 s_add_u32 s60, s60, 2
 s_cmp_ge_u32 s61, 8
 s_cbranch_scc1 LPa_w
 s_lshr_b32 s62, s24, 1
 s_lshl_b32 s62, s62, 3
 s_add_u32 s62, s62, s61
 s_mul_i32 s65, s62, 81920
 s_lshl_b32 s60, s60, 7
 s_add_u32 s65, s65, s60
 s_movk_i32 s64, 1280
 s_mov_b32 s4, s50
 s_mov_b32 s5, s51
 s_mov_b32 s6, 2621440
 s_branch LPa_go
LPa_w:
 s_sub_u32 s61, s61, 8
 s_cmp_ge_u32 s61, 5
 s_cselect_b32 s62, 640, 0
 s_addk_i32 s62, 1280
 s_lshl_b32 s61, s61, 7
 s_add_u32 s65, s61, s62
 s_add_u32 s65, s65, s63
 s_mul_i32 s60, s60, 245760
 s_add_u32 s65, s65, s60
 s_movk_i32 s64, 3840
 s_mov_b32 s4, s52
 s_mov_b32 s5, s53
 s_mov_b32 s6, 2457600
LPa_go:
 s_mov_b32 s7, 0x20000
 v_mul_u32_u24 v6, s64, v1
 buffer_load_dword v7, v6, s[4:7], s65 offen
 s_add_u32 s8, s8, 64
 s_cmp_lt_u32 s8, 128
 s_cbranch_scc1 LA_task
 s_barrier
 s_branch LA_kgen
LA_old0:
 s_setprio 2

 v_mul_u32_u24 v37, 1280, v1

LA_kgen:

 v_and_b32 v36, 31, v1
 v_mul_u32_u24 v36, 272, v36
 v_lshrrev_b32 v29, 5, v1
 v_lshl_add_u32 v36, v29, 4, v36
 v_add_u32 v36, s13, v36
 s_mov_b32 m0, s13

 v_mov_b32 v41, 0
 v_mov_b32 v42, 0
 v_mov_b32 v43, 0
 v_mov_b32 v44, 0
 v_mov_b32 v45, 0
 v_mov_b32 v46, 0
 v_mov_b32 v47, 0
 v_mov_b32 v48, 0
 v_mov_b32 v49, 0
 v_mov_b32 v50, 0
 v_mov_b32 v51, 0
 v_mov_b32 v52, 0
 v_mov_b32 v53, 0
 v_mov_b32 v54, 0
 v_mov_b32 v55, 0

 s_and_b32 s11, s10, 1
 s_lshl_b32 s11, s11, 4
 s_waitcnt lgkmcnt(0)
 s_lshr_b32 s14, s14, s11
 s_lshl_b32 s14, s14, 16
 s_lshr_b32 s15, s15, s11
 s_lshl_b32 s15, s15, 16
 v_mov_b32 v28, s14
 v_mul_f32 v28, 0x3fb8aa3b, v28
 v_exp_f32 v28, v28
 v_mov_b32 v29, s15
 v_cmp_eq_u32 vcc, 0, v1
 v_cvt_pk_bf16_f32 v28, v28, v28
 v_lshlrev_b32 v28, 16, v28
 v_cndmask_b32 v40, 0, v29, vcc
 s_mov_b32 s17, 0
 s_waitcnt vmcnt(0)

LA_round:
 v_lshlrev_b32 v29, 16, v2
 v_lshlrev_b32 v34, 16, v3
 v_add_f32 v30, v28, v28
 v_mul_f32 v29, 0x3fb8aa3b, v29
 v_mul_f32 v34, v34, v28
 v_lshlrev_b32 v72, 16, v4
 v_exp_f32 v29, v29
 v_mul_f32 v34, 0x3e22f983, v34
 v_lshlrev_b32 v73, 16, v5
 v_mul_f32 v72, v72, v30
 v_cvt_pk_bf16_f32 v29, v29, v29
 v_mul_f32 v59, 0x3f800000, v34
 v_mul_f32 v73, v73, v30
 v_lshlrev_b32 v29, 16, v29
 v_fract_f32 v59, v59
 v_mul_f32 v63, 0x43800000, v34
 v_mul_f32 v29, v29, v28
 v_cos_f32 v56, v59
 v_sin_f32 v57, v59
 v_mul_f32 v33, 0xbfb8aa3b, v29
 v_fract_f32 v63, v63
 v_mul_f32 v67, 0xc1000000, v34
 v_mul_f32 v58, 0x3f800000, v33
 v_mul_f32 v62, 0x43800000, v33
 v_cos_f32 v60, v63
 v_exp_f32 v58, v58
 v_exp_f32 v62, v62
 v_sin_f32 v61, v63
 v_cvt_pk_bf16_f32 v192, v72, v73
 v_mul_f32 v56, v56, v58
 v_mul_f32 v57, v57, v58
 v_mul_f32 v60, v60, v62
 v_mul_f32 v74, v72, v56
 v_mul_f32 v75, v73, v56
 v_mul_f32 v61, v61, v62
 v_fma_f32 v74, -v73, v57, v74
 v_fmac_f32 v75, v72, v57
 v_mul_f32 v66, 0x41000000, v33
 v_mul_f32 v76, v74, v56
 v_mul_f32 v77, v75, v56
 v_fract_f32 v67, v67
 v_fma_f32 v76, -v75, v57, v76
 v_fmac_f32 v77, v74, v57
 ds_write_addtid_b32 v192 offset:0
 v_mul_f32 v78, v76, v56
 v_mul_f32 v79, v77, v56
 v_exp_f32 v66, v66
 v_fma_f32 v78, -v77, v57, v78
 v_fmac_f32 v79, v76, v57
 v_cos_f32 v64, v67
 v_mul_f32 v80, v78, v56
 v_mul_f32 v81, v79, v56
 v_sin_f32 v65, v67
 v_fma_f32 v80, -v79, v57, v80
 v_fmac_f32 v81, v78, v57
 v_cvt_pk_bf16_f32 v195, v78, v79
 v_mul_f32 v82, v80, v56
 v_mul_f32 v83, v81, v56
 ds_write_addtid_b32 v195 offset:816
 v_fma_f32 v82, -v81, v57, v82
 v_fmac_f32 v83, v80, v57
 v_mul_f32 v64, v64, v66
 v_mul_f32 v84, v82, v56
 v_mul_f32 v85, v83, v56
 v_mul_f32 v65, v65, v66
 v_fma_f32 v84, -v83, v57, v84
 v_fmac_f32 v85, v82, v57
 v_mul_f32 v100, v64, v64
 v_mul_f32 v86, v84, v56
 v_mul_f32 v87, v85, v56
 v_cvt_pk_bf16_f32 v198, v84, v85
 v_fma_f32 v86, -v85, v57, v86
 v_fmac_f32 v87, v84, v57
 v_mul_f32 v101, v65, v64
 v_mul_f32 v88, v86, v56
 v_mul_f32 v89, v87, v56
 ds_write_addtid_b32 v198 offset:2720
 v_fma_f32 v88, -v87, v57, v88
 v_fmac_f32 v89, v86, v57
 v_fma_f32 v100, -v65, v65, v100
 v_mul_f32 v224, v88, v60
 v_mul_f32 v225, v89, v60
 v_fmac_f32 v101, v64, v65
 v_fma_f32 v224, -v89, v61, v224
 v_fmac_f32 v225, v88, v61
 v_mul_f32 v220, v72, v60
 v_mul_f32 v88, v224, v60
 v_mul_f32 v89, v225, v60
 v_cvt_pk_bf16_f32 v192, v224, v225
 v_fma_f32 v88, -v225, v61, v88
 v_fmac_f32 v89, v224, v61
 v_mul_f32 v221, v73, v60
 v_mul_f32 v224, v88, v60
 v_mul_f32 v225, v89, v60
 v_cvt_pk_bf16_f32 v195, v88, v89
 v_fma_f32 v224, -v89, v61, v224
 v_fmac_f32 v225, v88, v61
 v_mul_f32 v222, v80, v60
 v_mul_f32 v88, v224, v60
 v_mul_f32 v89, v225, v60
 v_cvt_pk_bf16_f32 v198, v224, v225
 v_fma_f32 v88, -v225, v61, v88
 v_fmac_f32 v89, v224, v61
 v_mul_f32 v223, v81, v60
 v_mul_f32 v224, v88, v60
 v_mul_f32 v225, v89, v60
 v_cvt_pk_bf16_f32 v199, v86, v87
 v_mul_f32 v228, v76, v60
 v_mul_f32 v229, v77, v60
 v_mul_f32 v102, v100, v64
 v_mul_f32 v103, v101, v64
 v_fma_f32 v220, -v73, v61, v220
 v_fmac_f32 v221, v72, v61
 v_fma_f32 v222, -v81, v61, v222
 v_fmac_f32 v223, v80, v61
 v_fma_f32 v224, -v89, v61, v224
 v_fmac_f32 v225, v88, v61
 ds_write_addtid_b32 v199 offset:2992
 v_fma_f32 v228, -v77, v61, v228
 v_fmac_f32 v229, v76, v61
 v_cvt_pk_bf16_f32 v196, v80, v81
 v_cvt_pk_bf16_f32 v199, v88, v89
 v_fma_f32 v102, -v101, v65, v102
 v_fmac_f32 v103, v100, v65
 v_mul_f32 v72, v220, v60
 v_mul_f32 v73, v221, v60
 v_mul_f32 v80, v222, v60
 v_mul_f32 v81, v223, v60
 v_mul_f32 v88, v224, v60
 v_mul_f32 v89, v225, v60
 v_cvt_pk_bf16_f32 v200, v228, v229
 v_mul_f32 v232, v84, v60
 v_mul_f32 v233, v85, v60
 v_mul_f32 v104, v102, v64
 v_mul_f32 v105, v103, v64
 v_fma_f32 v72, -v221, v61, v72
 v_fmac_f32 v73, v220, v61
 v_fma_f32 v80, -v223, v61, v80
 v_fmac_f32 v81, v222, v61
 v_fma_f32 v88, -v225, v61, v88
 v_fmac_f32 v89, v224, v61
 ds_write_addtid_b32 v200 offset:1632
 v_fma_f32 v232, -v85, v61, v232
 v_fmac_f32 v233, v84, v61
 v_cvt_pk_bf16_f32 v202, v220, v221
 v_cvt_pk_bf16_f32 v203, v222, v223
 v_cvt_pk_bf16_f32 v200, v224, v225
 v_fma_f32 v104, -v103, v65, v104
 v_fmac_f32 v105, v102, v65
 v_mul_f32 v71, 0xc2800000, v34
 v_mul_f32 v220, v72, v60
 v_mul_f32 v221, v73, v60
 v_mul_f32 v222, v80, v60
 v_mul_f32 v223, v81, v60
 v_mul_f32 v224, v88, v60
 v_mul_f32 v225, v89, v60
 v_cvt_pk_bf16_f32 v193, v74, v75
 v_cvt_pk_bf16_f32 v194, v76, v77
 v_cvt_pk_bf16_f32 v197, v82, v83
 v_cvt_pk_bf16_f32 v201, v232, v233
 v_mul_f32 v106, v104, v64
 v_mul_f32 v107, v105, v64
 v_mul_f32 v70, 0x42800000, v33
 v_fract_f32 v71, v71
 v_fma_f32 v220, -v73, v61, v220
 v_fmac_f32 v221, v72, v61
 v_fma_f32 v222, -v81, v61, v222
 v_fmac_f32 v223, v80, v61
 v_fma_f32 v224, -v89, v61, v224
 v_fmac_f32 v225, v88, v61
 ds_write_addtid_b32 v193 offset:272
 ds_write_addtid_b32 v194 offset:544
 ds_write_addtid_b32 v196 offset:2176
 ds_write_addtid_b32 v197 offset:2448
 ds_write_addtid_b32 v201 offset:3808
 ds_write_addtid_b32 v202 offset:1088
 ds_write_addtid_b32 v202 offset:1360
 v_fma_f32 v106, -v105, v65, v106
 v_fmac_f32 v107, v104, v65
 v_exp_f32 v70, v70
 v_cos_f32 v68, v71
 v_cvt_pk_bf16_f32 v193, v72, v73
 v_cvt_pk_bf16_f32 v194, v80, v81
 v_cvt_pk_bf16_f32 v196, v220, v221
 v_cvt_pk_bf16_f32 v197, v222, v223
 v_cvt_pk_bf16_f32 v201, v88, v89
 v_cvt_pk_bf16_f32 v202, v224, v225
 v_mul_f32 v108, v106, v64
 s_cmp_ge_u32 s20, 4
 s_cbranch_scc1 LA_yb
 s_cmp_lg_u32 s17, 1
 s_cbranch_scc1 LA_yb
 s_barrier
LA_yb:
 s_cmp_ge_u32 s20, 4
 s_cbranch_scc1 LA_um
 s_cmp_lg_u32 s17, 1
 s_cbranch_scc1 LA_um
 s_and_b32 s8, s25, 7
 s_lshl_b32 s8, s8, 2
 s_and_b32 s9, s20, 3
 s_add_u32 s8, s8, s9
 s_mul_i32 s8, s8, 81920
 s_add_u32 s8, s8, s16
 s_add_u32 s9, s8, 1310720
 s_cmp_ge_u32 s25, 24
 s_cselect_b32 s9, s9, 0x7000000
 v_mul_u32_u24 v6, 1280, v1

 buffer_load_dword v7, v6, s[68:71], s8 offen
LA_um:
 v_mul_f32 v109, v107, v64
 v_sin_f32 v69, v71
 ds_write_addtid_b32 v203 offset:1904
 ds_write_addtid_b32 v203 offset:3264
 ds_write_addtid_b32 v203 offset:3536
 ds_write_addtid_b32 v192 offset:4080
 ds_write_addtid_b32 v193 offset:4352
 ds_write_addtid_b32 v194 offset:4624
 ds_write_addtid_b32 v195 offset:4896
 ds_write_addtid_b32 v196 offset:5440
 ds_write_addtid_b32 v197 offset:5712
 ds_write_addtid_b32 v198 offset:5984
 ds_write_addtid_b32 v199 offset:6528
 ds_write_addtid_b32 v200 offset:7616
 ds_write_addtid_b32 v201 offset:7072
 ds_write_addtid_b32 v202 offset:8160
 v_mul_f32 v68, v68, v70
 ds_read_b128 v[128:131], v36 offset:0
 ds_read_b128 v[132:135], v36 offset:32
 v_fma_f32 v108, -v107, v65, v108
 v_fmac_f32 v109, v106, v65
 ds_read_b128 v[136:139], v36 offset:64
 v_mul_f32 v69, v69, v70
 ds_read_b128 v[140:143], v36 offset:96
 v_mul_f32 v204, v64, v68
 v_mul_f32 v205, v65, v68
 v_mul_f32 v206, v100, v68
 v_mul_f32 v207, v101, v68
 v_mul_f32 v208, v102, v68
 v_mul_f32 v209, v103, v68
 v_mul_f32 v210, v104, v68
 v_mul_f32 v211, v105, v68
 v_mul_f32 v212, v106, v68
 v_mul_f32 v213, v107, v68
 ds_read_b128 v[144:147], v36 offset:128
 v_mul_f32 v110, v108, v64
 v_mul_f32 v111, v109, v64
 v_mul_f32 v114, v68, v68
 ds_read_b128 v[148:151], v36 offset:160
 v_cvt_pk_bf16_f32 v203, v64, v65
 ds_read_b128 v[152:155], v36 offset:192
 v_fma_f32 v204, -v65, v69, v204
 v_fmac_f32 v205, v64, v69
 v_fma_f32 v206, -v101, v69, v206
 v_fmac_f32 v207, v100, v69
 v_fma_f32 v208, -v103, v69, v208
 v_fmac_f32 v209, v102, v69
 v_fma_f32 v210, -v105, v69, v210
 v_fmac_f32 v211, v104, v69
 v_fma_f32 v212, -v107, v69, v212
 v_fmac_f32 v213, v106, v69
 ds_read_b128 v[156:159], v36 offset:224
 v_fma_f32 v110, -v109, v65, v110
 v_fmac_f32 v111, v108, v65
 v_mul_f32 v115, v69, v68
 v_fma_f32 v114, -v69, v69, v114
 ds_write_addtid_b32 v203 offset:272
 v_cvt_pk_bf16_f32 v199, v204, v205
 v_cvt_pk_bf16_f32 v200, v206, v207
 v_cvt_pk_bf16_f32 v201, v208, v209
 v_cvt_pk_bf16_f32 v202, v210, v211
 v_cvt_pk_bf16_f32 v203, v212, v213
 v_mul_f32 v214, v108, v68
 v_mul_f32 v215, v109, v68
 v_mul_f32 v216, v110, v68
 v_mul_f32 v217, v111, v68
 v_fmac_f32 v115, v68, v69
 v_mul_f32 v218, v64, v114
 v_mul_f32 v219, v65, v114
 v_mul_f32 v204, v100, v114
 v_mul_f32 v205, v101, v114
 v_mul_f32 v206, v102, v114
 v_mul_f32 v207, v103, v114
 v_mul_f32 v208, v104, v114
 v_mul_f32 v209, v105, v114
 v_mul_f32 v210, v106, v114
 v_mul_f32 v211, v107, v114
 v_mul_f32 v212, v108, v114
 v_mul_f32 v213, v109, v114
 v_mul_f32 v118, v114, v68
 v_cvt_pk_bf16_f32 v192, v100, v101
 v_cvt_pk_bf16_f32 v193, v102, v103
 v_cvt_pk_bf16_f32 v195, v106, v107
 v_cvt_pk_bf16_f32 v196, v108, v109
 v_cvt_pk_bf16_f32 v197, v110, v111
 v_cvt_pk_bf16_f32 v198, v68, v69
 v_fma_f32 v214, -v109, v69, v214
 v_fmac_f32 v215, v108, v69
 v_fma_f32 v216, -v111, v69, v216
 v_fmac_f32 v217, v110, v69
 v_fma_f32 v218, -v65, v115, v218
 v_fmac_f32 v219, v64, v115
 v_fma_f32 v204, -v101, v115, v204
 v_fmac_f32 v205, v100, v115
 v_fma_f32 v206, -v103, v115, v206
 v_fmac_f32 v207, v102, v115
 v_fma_f32 v208, -v105, v115, v208
 v_fmac_f32 v209, v104, v115
 v_fma_f32 v210, -v107, v115, v210
 v_fmac_f32 v211, v106, v115
 v_fma_f32 v212, -v109, v115, v212
 v_fmac_f32 v213, v108, v115
 v_mul_f32 v119, v115, v68
 v_fma_f32 v118, -v115, v69, v118
 ds_write_addtid_b32 v192 offset:544
 ds_write_addtid_b32 v193 offset:816
 v_cvt_pk_bf16_f32 v194, v104, v105
 ds_write_addtid_b32 v195 offset:1360
 ds_write_addtid_b32 v196 offset:1632
 ds_write_addtid_b32 v197 offset:1904
 ds_write_addtid_b32 v198 offset:2176
 ds_write_addtid_b32 v199 offset:2448
 ds_write_addtid_b32 v200 offset:2720
 v_cvt_pk_bf16_f32 v192, v214, v215
 v_cvt_pk_bf16_f32 v193, v216, v217
 v_cvt_pk_bf16_f32 v195, v218, v219
 v_cvt_pk_bf16_f32 v196, v204, v205
 v_cvt_pk_bf16_f32 v197, v206, v207
 v_cvt_pk_bf16_f32 v198, v208, v209
 v_cvt_pk_bf16_f32 v199, v210, v211
 v_cvt_pk_bf16_f32 v200, v212, v213
 v_mul_f32 v214, v110, v114
 v_mul_f32 v215, v111, v114
 v_fmac_f32 v119, v114, v69
 v_mul_f32 v216, v64, v118
 v_mul_f32 v217, v65, v118
 v_mul_f32 v218, v100, v118
 v_mul_f32 v219, v101, v118
 v_mul_f32 v204, v102, v118
 v_mul_f32 v205, v103, v118
 v_mul_f32 v206, v104, v118
 v_mul_f32 v207, v105, v118
 v_mul_f32 v208, v106, v118
 v_mul_f32 v209, v107, v118
 v_mul_f32 v210, v108, v118
 v_mul_f32 v211, v109, v118
 v_mul_f32 v212, v110, v118
 v_mul_f32 v213, v111, v118
 ds_write_addtid_b32 v194 offset:1088
 v_cvt_pk_bf16_f32 v194, v114, v115
 v_fma_f32 v214, -v111, v115, v214
 v_fmac_f32 v215, v110, v115
 v_fma_f32 v216, -v65, v119, v216
 v_fmac_f32 v217, v64, v119
 v_fma_f32 v218, -v101, v119, v218
 v_fmac_f32 v219, v100, v119
 v_fma_f32 v204, -v103, v119, v204
 v_fmac_f32 v205, v102, v119
 v_fma_f32 v206, -v105, v119, v206
 v_fmac_f32 v207, v104, v119
 v_fma_f32 v208, -v107, v119, v208
 v_fmac_f32 v209, v106, v119
 v_fma_f32 v210, -v109, v119, v210
 v_fmac_f32 v211, v108, v119
 v_fma_f32 v212, -v111, v119, v212
 v_fmac_f32 v213, v110, v119
 ds_write_addtid_b32 v201 offset:2992
 ds_write_addtid_b32 v202 offset:3264
 ds_write_addtid_b32 v203 offset:3536
 ds_write_addtid_b32 v192 offset:3808
 ds_write_addtid_b32 v193 offset:4080
 ds_write_addtid_b32 v194 offset:4352
 ds_write_addtid_b32 v195 offset:4624
 ds_write_addtid_b32 v196 offset:4896
 ds_write_addtid_b32 v197 offset:5168
 v_mov_b32 v122, 0x3f80
 v_cvt_pk_bf16_f32 v201, v214, v215
 v_cvt_pk_bf16_f32 v202, v118, v119
 v_cvt_pk_bf16_f32 v203, v216, v217
 v_cvt_pk_bf16_f32 v192, v218, v219
 v_cvt_pk_bf16_f32 v193, v204, v205
 v_cvt_pk_bf16_f32 v194, v206, v207
 v_cvt_pk_bf16_f32 v195, v208, v209
 v_cvt_pk_bf16_f32 v196, v210, v211
 v_cvt_pk_bf16_f32 v197, v212, v213
 ds_write_addtid_b32 v122 offset:0
 ds_write_addtid_b32 v198 offset:5440
 ds_write_addtid_b32 v199 offset:5712
 ds_write_addtid_b32 v200 offset:5984
 ds_write_addtid_b32 v201 offset:6256
 ds_write_addtid_b32 v202 offset:6528
 ds_write_addtid_b32 v203 offset:6800
 ds_write_addtid_b32 v192 offset:7072
 ds_write_addtid_b32 v193 offset:7344
 ds_write_addtid_b32 v194 offset:7616
 ds_write_addtid_b32 v195 offset:7888
 ds_write_addtid_b32 v196 offset:8160
 ds_write_addtid_b32 v197 offset:8432
 s_cmp_ge_u32 s20, 4
 s_cbranch_scc1 LA_ub
 s_cmp_lg_u32 s17, 0
 s_cbranch_scc1 LA_ua
 s_and_b32 s8, s25, 7
 s_lshl_b32 s8, s8, 2
 s_and_b32 s9, s20, 3
 s_add_u32 s8, s8, s9
 s_mul_i32 s8, s8, 81920
 s_add_u32 s8, s8, s16
 s_add_u32 s9, s8, 1310720
 s_cmp_ge_u32 s25, 24
 s_cselect_b32 s9, s9, 0x7000000
 v_mul_u32_u24 v6, 1280, v1

 buffer_load_dword v7, v6, s[68:71], s9 offen
 s_branch LA_ub
LA_ua:
LA_ub:
 ds_read_b128 v[160:163], v36 offset:0
 ds_read_b128 v[164:167], v36 offset:32
 ds_read_b128 v[168:171], v36 offset:64
 ds_read_b128 v[172:175], v36 offset:96
 ds_read_b128 v[176:179], v36 offset:128
 ds_read_b128 v[180:183], v36 offset:160
 ds_read_b128 v[184:187], v36 offset:192
 ds_read_b128 v[188:191], v36 offset:224
 v_lshrrev_b32 v2, 16, v2
 v_lshrrev_b32 v3, 16, v3
 v_lshrrev_b32 v4, 16, v4
 v_lshrrev_b32 v5, 16, v5
 s_waitcnt lgkmcnt(7)
 v_mfma_f32_32x32x16_bf16 v[40:55], v[128:131], v[160:163], v[40:55]
 s_waitcnt lgkmcnt(6)
 v_mfma_f32_32x32x16_bf16 v[40:55], v[132:135], v[164:167], v[40:55]
 s_waitcnt lgkmcnt(5)
 v_mfma_f32_32x32x16_bf16 v[40:55], v[136:139], v[168:171], v[40:55]
 s_waitcnt lgkmcnt(4)
 v_mfma_f32_32x32x16_bf16 v[40:55], v[140:143], v[172:175], v[40:55]
 s_waitcnt lgkmcnt(3)
 v_mfma_f32_32x32x16_bf16 v[40:55], v[144:147], v[176:179], v[40:55]
 s_waitcnt lgkmcnt(2)
 v_mfma_f32_32x32x16_bf16 v[40:55], v[148:151], v[180:183], v[40:55]
 s_waitcnt lgkmcnt(1)
 v_mfma_f32_32x32x16_bf16 v[40:55], v[152:155], v[184:187], v[40:55]
 s_waitcnt lgkmcnt(0)
 v_mfma_f32_32x32x16_bf16 v[40:55], v[156:159], v[188:191], v[40:55]
 s_add_u32 s17, s17, 1
 s_cmp_lt_u32 s17, 2
 s_cbranch_scc1 LA_round

 v_lshlrev_b32 v29, 4, v1
 v_sub_u32 v56, 1008, v29
 v_add_u32 v56, s13, v56
 v_and_b32 v29, 1, v1
 v_cmp_eq_u32 vcc, 0, v29
 v_and_b32 v29, 15, v1
 v_lshrrev_b32 v33, 4, v1
 v_lshlrev_b32 v30, 4, v33
 v_add_u32 v30, s13, v30
 v_mov_b32 v31, 4288
 v_cndmask_b32 v57, 60, v31, vcc
 v_lshlrev_b32 v32, 2, v29
 v_sub_u32 v57, v57, v32
 v_add_u32 v57, v57, v30
 v_lshl_add_u32 v59, v33, 7, v32
 v_mov_b32 v31, 13280
 v_mov_b32 v32, 8704
 v_cndmask_b32 v58, v32, v31, vcc
 v_lshrrev_b32 v29, 1, v29
 v_lshl_add_u32 v58, v29, 6, v58
 v_add_u32 v58, v58, v30

 v_cvt_pk_bf16_f32 v96, v47, v46
 v_cvt_pk_bf16_f32 v97, v45, v44
 v_cvt_pk_bf16_f32 v98, v43, v42
 v_cvt_pk_bf16_f32 v99, v41, v40
 ds_write_b128 v56, v[96:99] offset:3072
 ds_write_b32 v56, v96 offset:7300
 ds_write_b32 v56, v97 offset:7304
 ds_write_b32 v56, v98 offset:7308
 ds_write_b32 v56, v99 offset:7312
 v_cvt_pk_bf16_f32 v100, v50, v50
 v_cvt_pk_bf16_f32 v101, v49, v49
 v_cvt_pk_bf16_f32 v102, v49, v48
 v_cvt_pk_bf16_f32 v103, v48, v48
 ds_write_b128 v56, v[100:103] offset:2048
 ds_write_b32 v56, v100 offset:6276
 ds_write_b32 v56, v101 offset:6280
 ds_write_b32 v56, v102 offset:6284
 ds_write_b32 v56, v103 offset:6288
 v_readlane_b32 s11, v50, 63
 v_cmp_eq_u32 vcc, 0, v1
 v_mov_b32 v104, 0
 v_lshlrev_b32 v31, 1, v1
 v_mov_b32 v29, s11
 v_sub_u32 v31, 1150, v31
 v_cndmask_b32 v29, 0, v29, vcc
 v_add_u32 v31, s13, v31
 v_cvt_pk_bf16_f32 v105, v104, v29
 v_cvt_pk_bf16_f32 v106, v29, v29
 v_cvt_pk_bf16_f32 v108, v52, v54
 v_mov_b32 v107, v106
 s_mov_b64 exec, 0xff
 ds_write_b128 v56, v[104:107] offset:1024
 ds_write_b32 v56, v104 offset:5252
 ds_write_b32 v56, v105 offset:5256
 ds_write_b32 v56, v106 offset:5260
 ds_write_b32 v56, v107 offset:5264
 s_mov_b64 exec, -1
 ds_write_b16 v31, v108 offset:128
 ds_write_b16 v31, v108 offset:4356
 ds_write_b16_d16_hi v31, v108
 ds_write_b16_d16_hi v31, v108 offset:4228

 v_mov_b32 v32, 0
 v_min_u32 v29, 62, v1
 v_lshlrev_b32 v29, 2, v29
 v_cmp_lt_u32 vcc, 31, v1
 v_mov_b32 v30, 4100
 v_bfe_u32 v31, v1, 2, 2
 v_cndmask_b32 v30, 0, v30, vcc
 v_add3_u32 v29, v29, v30, s13
 ds_write_b32 v29, v32 offset:4096
 ds_write_b32 v29, v32 offset:1280
 v_and_b32 v32, 3, v1
 v_lshlrev_b32 v32, 3, v32
 v_lshl_add_u32 v32, v33, 5, v32
 s_lshl_b32 s11, s20, 7
 v_add_u32 v32, s11, v32
 v_mul_u32_u24 v60, 17872, v31
 v_add_u32 v60, v60, v32
 v_mul_u32_u24 v61, 2624, v31
 v_add_u32 v61, v61, v32
 v_add_u32 v61, 142976, v61
 v_mul_u32_u24 v62, 2560, v0
 v_mov_b32 v64, 0
 v_mov_b32 v65, 0
 v_mov_b32 v66, 0
 v_mov_b32 v67, 0
 v_mov_b32 v68, 0
 v_mov_b32 v69, 0
 v_mov_b32 v70, 0
 v_mov_b32 v71, 0
 v_mov_b32 v72, 0
 v_mov_b32 v73, 0
 v_mov_b32 v74, 0
 v_mov_b32 v75, 0
 v_mov_b32 v76, 0
 v_mov_b32 v77, 0
 v_mov_b32 v78, 0
 v_mov_b32 v79, 0
 v_and_b32 v20, 15, v1
 v_lshlrev_b32 v21, 3, v33
 v_lshlrev_b32 v16, 4, v33
 v_lshl_add_u32 v17, v20, 6, v16
 v_lshl_add_u32 v16, v20, 5, v16
 s_add_u32 s11, s13, 9104
 v_add_u32 v16, s11, v16
 v_add_u32 v17, s13, v17
 v_lshl_add_u32 v18, v59, 1, s13
 s_mov_b32 s11, 0x3f800000
 v_mov_b32 v22, 8176
 v_lshlrev_b32 v22, v20, v22
 v_lshrrev_b32 v22, v21, v22
 v_bfe_i32 v23, v22, 0, 1
 v_bfe_i32 v24, v22, 1, 1
 v_and_b32 v23, 0x3f80, v23
 v_and_or_b32 v8, v24, s11, v23
 v_bfe_i32 v23, v22, 2, 1
 v_bfe_i32 v24, v22, 3, 1
 v_and_b32 v23, 0x3f80, v23
 v_and_or_b32 v9, v24, s11, v23
 v_bfe_i32 v23, v22, 4, 1
 v_bfe_i32 v24, v22, 5, 1
 v_and_b32 v23, 0x3f80, v23
 v_and_or_b32 v10, v24, s11, v23
 v_bfe_i32 v23, v22, 6, 1
 v_bfe_i32 v24, v22, 7, 1
 v_and_b32 v23, 0x3f80, v23
 v_and_or_b32 v11, v24, s11, v23
 v_mov_b32 v22, 4064
 v_lshlrev_b32 v22, v20, v22
 v_lshrrev_b32 v22, v21, v22
 v_bfe_i32 v23, v22, 0, 1
 v_bfe_i32 v24, v22, 1, 1
 v_and_b32 v23, 0x3f80, v23
 v_and_or_b32 v12, v24, s11, v23
 v_bfe_i32 v23, v22, 2, 1
 v_bfe_i32 v24, v22, 3, 1
 v_and_b32 v23, 0x3f80, v23
 v_and_or_b32 v13, v24, s11, v23
 v_bfe_i32 v23, v22, 4, 1
 v_bfe_i32 v24, v22, 5, 1
 v_and_b32 v23, 0x3f80, v23
 v_and_or_b32 v14, v24, s11, v23
 v_bfe_i32 v23, v22, 6, 1
 v_bfe_i32 v24, v22, 7, 1
 v_and_b32 v23, 0x3f80, v23
 v_and_or_b32 v15, v24, s11, v23
 s_cmp_ge_u32 s20, 4
 s_cbranch_scc1 LA_young
 v_and_b32 v29, 48, v1
 v_bfe_u32 v30, v1, 2, 2
 v_and_b32 v31, 2, v1
 v_lshl_add_u32 v31, v31, 2, v29
 v_add_u32 v30, v30, v31
 v_lshlrev_b32 v30, 4, v30
 v_and_b32 v31, 1, v1
 v_lshl_add_u32 v40, v31, 3, v30
 v_add_u32 v42, s13, v40
 v_add_u32 v43, 71488, v42
 s_mul_i32 s11, s20, 5152
 s_add_u32 s11, s11, 142976
 v_add_u32 v40, s11, v40
 v_and_b32 v30, 7, v1
 v_mul_u32_u24 v41, 17872, v30
 v_and_b32 v30, 56, v1
 v_lshl_add_u32 v41, v30, 1, v41
 v_mov_b32 v39, 1
 s_mul_i32 s8, s20, 409600
 s_add_u32 s8, s8, s16
 s_mul_i32 s18, s20, 5152
 s_mul_i32 s19, s20, 245760
 s_add_u32 s19, s19, s16
 s_add_u32 m0, s18, 142976
 s_sub_u32 s9, s8, 1280
 s_cselect_b32 s9, 0x7000000, s9
 s_mov_b64 exec, 1
 buffer_load_dwordx4 v37, s[68:71], s9 offen lds
 s_add_u32 m0, s13, 11712
 s_add_u32 s9, s19, 1637120
 buffer_load_dwordx4 v37, s[68:71], s9 offen lds
 s_add_u32 m0, s13, 16288
 s_add_u32 s9, s19, 1719040
 buffer_load_dwordx4 v37, s[68:71], s9 offen lds
 s_add_u32 m0, s13, 83200
 s_add_u32 s9, s19, 1800960
 buffer_load_dwordx4 v37, s[68:71], s9 offen lds
 s_mov_b64 exec, -1
 s_add_u32 m0, s18, 142992
 s_add_u32 s9, s8, 0
 buffer_load_dwordx4 v37, s[68:71], s9 offen lds
 s_add_u32 m0, s18, 144016
 s_add_u32 s9, s8, 81920
 buffer_load_dwordx4 v37, s[68:71], s9 offen lds
 s_add_u32 m0, s18, 145040
 s_add_u32 s9, s8, 163840
 buffer_load_dwordx4 v37, s[68:71], s9 offen lds
 s_add_u32 m0, s18, 146064
 s_add_u32 s9, s8, 245760
 buffer_load_dwordx4 v37, s[68:71], s9 offen lds
 s_add_u32 m0, s18, 147088
 s_add_u32 s9, s8, 327680
 buffer_load_dwordx4 v37, s[68:71], s9 offen lds
 s_mov_b32 m0, s13
 s_mul_i32 s11, s20, 384
 s_add_u32 s11, s11, 11712
 v_add_u32 v44, s11, v41
 s_mul_i32 s11, s20, 640
 s_add_u32 s11, s11, 9152
 v_add_u32 v41, s11, v41
 v_min_u32 v29, 55, v1
 v_lshlrev_b32 v29, 3, v29
 v_add_u32 v29, s13, v29
 ds_write_b64 v29, v[64:65] offset:8704
 ds_write_b64 v29, v[64:65] offset:13280
 s_waitcnt vmcnt(4)
 ds_read_b64_tr_b16 v[128:129], v40 offset:16
 ds_read_b64_tr_b16 v[130:131], v40 offset:80
 ds_read_b64_tr_b16 v[132:133], v40 offset:0
 ds_read_b64_tr_b16 v[134:135], v40 offset:64
 s_waitcnt lgkmcnt(0)
 ds_write_b128 v41, v[128:131] offset:0
 ds_write_b128 v41, v[132:135] offset:4576
 s_waitcnt vmcnt(3)
 ds_read_b64_tr_b16 v[136:137], v40 offset:1040
 ds_read_b64_tr_b16 v[138:139], v40 offset:1104
 ds_read_b64_tr_b16 v[140:141], v40 offset:1024
 ds_read_b64_tr_b16 v[142:143], v40 offset:1088
 s_waitcnt lgkmcnt(0)
 ds_write_b128 v41, v[136:139] offset:128
 ds_write_b128 v41, v[140:143] offset:4704
 s_waitcnt vmcnt(2)
 ds_read_b64_tr_b16 v[144:145], v40 offset:2064
 ds_read_b64_tr_b16 v[146:147], v40 offset:2128
 ds_read_b64_tr_b16 v[148:149], v40 offset:2048
 ds_read_b64_tr_b16 v[150:151], v40 offset:2112
 s_waitcnt lgkmcnt(0)
 ds_write_b128 v41, v[144:147] offset:256
 ds_write_b128 v41, v[148:151] offset:4832
 s_waitcnt vmcnt(1)
 ds_read_b64_tr_b16 v[152:153], v40 offset:3088
 ds_read_b64_tr_b16 v[154:155], v40 offset:3152
 ds_read_b64_tr_b16 v[156:157], v40 offset:3072
 ds_read_b64_tr_b16 v[158:159], v40 offset:3136
 s_waitcnt lgkmcnt(0)
 ds_write_b128 v41, v[152:155] offset:384
 ds_write_b128 v41, v[156:159] offset:4960
 s_waitcnt vmcnt(0)
 s_add_u32 m0, s13, 11728
 s_add_u32 s9, s19, 1638400
 buffer_load_dwordx4 v37, s[68:71], s9 offen lds
 s_add_u32 m0, s13, 16304
 s_add_u32 s9, s19, 1720320
 buffer_load_dwordx4 v37, s[68:71], s9 offen lds
 s_add_u32 m0, s13, 83216
 s_add_u32 s9, s19, 1802240
 buffer_load_dwordx4 v37, s[68:71], s9 offen lds
 ds_read_b64_tr_b16 v[160:161], v40 offset:4112
 ds_read_b64_tr_b16 v[162:163], v40 offset:4176
 ds_read_b64_tr_b16 v[164:165], v40 offset:4096
 ds_read_b64_tr_b16 v[166:167], v40 offset:4160
 s_waitcnt lgkmcnt(0)
 ds_write_b128 v41, v[160:163] offset:512
 ds_write_b128 v41, v[164:167] offset:5088
 s_waitcnt lgkmcnt(0)
 s_mov_b64 exec, 1
 ds_add_u32 v38, v39
 s_mov_b64 exec, -1
LA_s0:
 ds_read_b32 v34, v38
 s_waitcnt lgkmcnt(0)
 v_readfirstlane_b32 s11, v34
 s_nop 0
 s_cmp_lt_u32 s11, 4
 s_cbranch_scc1 LA_s0
 s_sub_u32 s8, s25, 16
 s_lshl_b32 s8, s8, 3
 s_add_u32 s8, s8, s20
 s_add_u32 s8, s8, 0
 s_min_u32 s8, s8, 49
 s_mul_i32 s9, s8, 13108
 s_lshr_b32 s9, s9, 16
 s_mul_i32 s9, s9, 81280
 s_lshl_b32 s8, s8, 7
 s_add_u32 s8, s8, s9
 s_and_b32 s9, s24, 1
 s_mul_i32 s9, s9, 640
 s_add_u32 s8, s8, s9
 v_mul_u32_u24 v6, 1280, v1
 v_add_u32 v6, s8, v6
 global_load_dword v7, v6, s[54:55]
 s_sub_u32 s8, s25, 16
 s_lshl_b32 s8, s8, 3
 s_add_u32 s8, s8, s20
 s_add_u32 s8, s8, 4
 s_min_u32 s8, s8, 49
 s_mul_i32 s9, s8, 13108
 s_lshr_b32 s9, s9, 16
 s_mul_i32 s9, s9, 81280
 s_lshl_b32 s8, s8, 7
 s_add_u32 s8, s8, s9
 s_and_b32 s9, s24, 1
 s_mul_i32 s9, s9, 640
 s_add_u32 s8, s8, s9
 v_mul_u32_u24 v6, 1280, v1
 v_add_u32 v6, s8, v6
 global_load_dword v7, v6, s[54:55]
 ds_read_b128 v[128:131], v16 offset:0
 ds_read_b128 v[132:135], v16 offset:16
 ds_read_b128 v[136:139], v16 offset:512
 ds_read_b128 v[140:143], v16 offset:528
 ds_read_b128 v[144:147], v16 offset:1024
 ds_read_b128 v[148:151], v16 offset:1040
 ds_read_b128 v[152:155], v16 offset:1536
 ds_read_b128 v[156:159], v16 offset:1552
 ds_read_b64 v[240:241], v57 offset:1920
 ds_read_b64 v[242:243], v57 offset:1928
 ds_read_b128 v[192:195], v58 offset:384
 ds_read_b128 v[196:199], v58 offset:896
 ds_read_b128 v[200:203], v58 offset:1408
 ds_read_b128 v[204:207], v58 offset:1920
 s_waitcnt lgkmcnt(12)
 v_mfma_f32_16x16x32_bf16 v[160:163], v[128:131], v[8:11], 0
 ds_read_b64 v[244:245], v57 offset:1984
 ds_read_b64 v[246:247], v57 offset:1992
 v_mfma_f32_16x16x32_bf16 v[164:167], v[132:135], v[12:15], 0
 ds_read_b128 v[208:211], v58 offset:448
 ds_read_b128 v[212:215], v58 offset:960
 s_waitcnt lgkmcnt(14)
 v_mfma_f32_16x16x32_bf16 v[168:171], v[136:139], v[8:11], 0
 ds_read_b128 v[216:219], v58 offset:1472
 ds_read_b128 v[220:223], v58 offset:1984
 v_mfma_f32_16x16x32_bf16 v[172:175], v[140:143], v[12:15], 0
 ds_read_b64 v[96:97], v57 offset:1216
 ds_read_b64 v[98:99], v57 offset:1224
 s_waitcnt lgkmcnt(15)
 v_mfma_f32_16x16x32_bf16 v[176:179], v[144:147], v[8:11], 0
 ds_read_b64 v[100:101], v57 offset:1152
 ds_read_b64 v[102:103], v57 offset:1160
 v_mfma_f32_16x16x32_bf16 v[180:183], v[148:151], v[12:15], 0
 ds_read_b64 v[104:105], v57 offset:1088
 ds_read_b64 v[106:107], v57 offset:1096
 s_waitcnt lgkmcnt(15)
 v_mfma_f32_16x16x32_bf16 v[184:187], v[152:155], v[8:11], 0
 ds_read_b64 v[108:109], v57 offset:1024
 ds_read_b64 v[110:111], v57 offset:1032
 v_mfma_f32_16x16x32_bf16 v[188:191], v[156:159], v[12:15], 0
 s_waitcnt lgkmcnt(8)
 v_mfma_f32_16x16x32_bf16 v[80:83], v[192:195], v[240:243], 0
 v_cvt_pk_bf16_f32 v112, v160, v164
 v_cvt_pk_bf16_f32 v113, v161, v165
 v_mfma_f32_16x16x32_bf16 v[84:87], v[196:199], v[240:243], 0
 v_cvt_pk_bf16_f32 v114, v162, v166
 v_cvt_pk_bf16_f32 v115, v163, v167
 v_mfma_f32_16x16x32_bf16 v[88:91], v[200:203], v[240:243], 0
 v_cvt_pk_bf16_f32 v116, v168, v172
 v_cvt_pk_bf16_f32 v117, v169, v173
 v_mfma_f32_16x16x32_bf16 v[92:95], v[204:207], v[240:243], 0
 v_cvt_pk_bf16_f32 v118, v170, v174
 v_cvt_pk_bf16_f32 v119, v171, v175
 v_mfma_f32_16x16x32_bf16 v[80:83], v[208:211], v[244:247], v[80:83]
 v_cvt_pk_bf16_f32 v120, v176, v180
 v_cvt_pk_bf16_f32 v121, v177, v181
 v_mfma_f32_16x16x32_bf16 v[84:87], v[212:215], v[244:247], v[84:87]
 v_cvt_pk_bf16_f32 v122, v178, v182
 v_cvt_pk_bf16_f32 v123, v179, v183
 v_mfma_f32_16x16x32_bf16 v[88:91], v[216:219], v[244:247], v[88:91]
 v_cvt_pk_bf16_f32 v124, v184, v188
 v_cvt_pk_bf16_f32 v125, v185, v189
 v_mfma_f32_16x16x32_bf16 v[92:95], v[220:223], v[244:247], v[92:95]
 v_cvt_pk_bf16_f32 v126, v186, v190
 v_cvt_pk_bf16_f32 v127, v187, v191
 s_waitcnt lgkmcnt(0)
 v_mfma_f32_16x16x32_bf16 v[128:131], v[112:115], v[96:99], 0
 v_mfma_f32_16x16x32_bf16 v[132:135], v[116:119], v[96:99], 0
 v_mfma_f32_16x16x32_bf16 v[132:135], v[112:115], v[100:103], v[132:135]
 v_mfma_f32_16x16x32_bf16 v[136:139], v[120:123], v[96:99], 0
 v_mfma_f32_16x16x32_bf16 v[136:139], v[116:119], v[100:103], v[136:139]
 v_mfma_f32_16x16x32_bf16 v[136:139], v[112:115], v[104:107], v[136:139]
 v_mfma_f32_16x16x32_bf16 v[140:143], v[124:127], v[96:99], 0
 v_mfma_f32_16x16x32_bf16 v[140:143], v[120:123], v[100:103], v[140:143]
 v_mfma_f32_16x16x32_bf16 v[140:143], v[116:119], v[104:107], v[140:143]
 v_mfma_f32_16x16x32_bf16 v[140:143], v[112:115], v[108:111], v[140:143]
 ds_write_b128 v17, v[128:131] offset:0
 ds_read_b64 v[224:225], v18 offset:0
 ds_read_b64 v[226:227], v18 offset:128
 ds_write_b128 v17, v[132:135] offset:4224
 ds_read_b64 v[228:229], v18 offset:4224
 ds_read_b64 v[230:231], v18 offset:4352
 ds_write_b128 v17, v[136:139] offset:0
 ds_read_b64 v[232:233], v18 offset:0
 ds_read_b64 v[234:235], v18 offset:128
 ds_write_b128 v17, v[140:143] offset:4224
 ds_read_b64 v[236:237], v18 offset:4224
 ds_read_b64 v[238:239], v18 offset:4352
 s_waitcnt vmcnt(2)
 ds_read_b64_tr_b16 v[168:169], v42 offset:11728
 ds_read_b64_tr_b16 v[170:171], v42 offset:11792
 ds_read_b64_tr_b16 v[172:173], v42 offset:11712
 ds_read_b64_tr_b16 v[174:175], v42 offset:11776
 ds_read_b64_tr_b16 v[176:177], v42 offset:16304
 ds_read_b64_tr_b16 v[178:179], v42 offset:16368
 ds_read_b64_tr_b16 v[180:181], v42 offset:16288
 ds_read_b64_tr_b16 v[182:183], v42 offset:16352
 ds_read_b64_tr_b16 v[184:185], v43 offset:11728
 ds_read_b64_tr_b16 v[186:187], v43 offset:11792
 ds_read_b64_tr_b16 v[188:189], v43 offset:11712
 ds_read_b64_tr_b16 v[190:191], v43 offset:11776
 s_waitcnt lgkmcnt(0)
 s_mov_b64 exec, 1
 ds_add_u32 v38, v39
 s_mov_b64 exec, -1
LA_s1:
 ds_read_b32 v34, v38
 s_waitcnt lgkmcnt(0)
 v_readfirstlane_b32 s11, v34
 s_nop 0
 s_cmp_lt_u32 s11, 8
 s_cbranch_scc1 LA_s1
 ds_write_b128 v44, v[168:171] offset:0
 ds_write_b128 v44, v[172:175] offset:4576
 ds_write_b128 v44, v[176:179] offset:128
 ds_write_b128 v44, v[180:183] offset:4704
 ds_write_b128 v44, v[184:187] offset:256
 ds_write_b128 v44, v[188:191] offset:4832
 s_waitcnt lgkmcnt(0)
 s_mov_b64 exec, 1
 ds_add_u32 v38, v39
 s_mov_b64 exec, -1
LA_s2:
 ds_read_b32 v34, v38
 s_waitcnt lgkmcnt(0)
 v_readfirstlane_b32 s11, v34
 s_nop 0
 s_cmp_lt_u32 s11, 12
 s_cbranch_scc1 LA_s2
 s_waitcnt lgkmcnt(0)
 ds_read_b128 v[128:131], v58 offset:0
 ds_read_b64 v[96:97], v57 offset:3584
 ds_read_b64 v[98:99], v57 offset:3592
 ds_read_b128 v[132:135], v58 offset:512
 ds_read_b64 v[100:101], v57 offset:3072
 ds_read_b64 v[102:103], v57 offset:3080
 ds_read_b128 v[136:139], v58 offset:1024
 ds_read_b64 v[104:105], v57 offset:2560
 ds_read_b64 v[106:107], v57 offset:2568
 ds_read_b128 v[140:143], v58 offset:1536
 ds_read_b64 v[108:109], v57 offset:2048
 ds_read_b64 v[110:111], v57 offset:2056
 ds_read_b128 v[144:147], v58 offset:2048
 ds_read_b128 v[148:151], v58 offset:2560
 ds_read_b128 v[152:155], v58 offset:3072
 ds_read_b128 v[156:159], v58 offset:3584
 s_mov_b32 s17, 0
LA_convF:
 s_waitcnt lgkmcnt(7)
 v_mfma_f32_16x16x32_bf16 v[64:67], v[128:131], v[96:99], v[64:67]
 ds_read_b128 v[192:195], v58 offset:64
 v_mfma_f32_16x16x32_bf16 v[68:71], v[132:135], v[96:99], v[68:71]
 ds_read_b64 v[160:161], v57 offset:3648
 v_mfma_f32_16x16x32_bf16 v[68:71], v[128:131], v[100:103], v[68:71]
 v_mfma_f32_16x16x32_bf16 v[72:75], v[132:135], v[100:103], v[72:75]
 ds_read_b64 v[162:163], v57 offset:3656
 v_mfma_f32_16x16x32_bf16 v[72:75], v[136:139], v[96:99], v[72:75]
 ds_read_b128 v[196:199], v58 offset:576
 v_mfma_f32_16x16x32_bf16 v[72:75], v[128:131], v[104:107], v[72:75]
 v_mfma_f32_16x16x32_bf16 v[76:79], v[136:139], v[100:103], v[76:79]
 ds_read_b64 v[164:165], v57 offset:3136
 v_mfma_f32_16x16x32_bf16 v[76:79], v[132:135], v[104:107], v[76:79]
 ds_read_b64 v[166:167], v57 offset:3144
 v_mfma_f32_16x16x32_bf16 v[80:83], v[136:139], v[104:107], v[80:83]
 s_waitcnt lgkmcnt(10)
 v_mfma_f32_16x16x32_bf16 v[76:79], v[140:143], v[96:99], v[76:79]
 ds_read_b128 v[200:203], v58 offset:1088
 v_mfma_f32_16x16x32_bf16 v[76:79], v[128:131], v[108:111], v[76:79]
 ds_read_b64 v[168:169], v57 offset:2624
 v_mfma_f32_16x16x32_bf16 v[80:83], v[140:143], v[100:103], v[80:83]
 v_mfma_f32_16x16x32_bf16 v[80:83], v[132:135], v[108:111], v[80:83]
 ds_read_b64 v[170:171], v57 offset:2632
 v_mfma_f32_16x16x32_bf16 v[84:87], v[140:143], v[104:107], v[84:87]
 v_mfma_f32_16x16x32_bf16 v[84:87], v[136:139], v[108:111], v[84:87]
 ds_read_b128 v[204:207], v58 offset:1600
 v_mfma_f32_16x16x32_bf16 v[88:91], v[140:143], v[108:111], v[88:91]
 ds_read_b64 v[172:173], v57 offset:2112
 s_waitcnt lgkmcnt(13)
 v_mfma_f32_16x16x32_bf16 v[80:83], v[144:147], v[96:99], v[80:83]
 v_mfma_f32_16x16x32_bf16 v[84:87], v[144:147], v[100:103], v[84:87]
 ds_read_b64 v[174:175], v57 offset:2120
 v_mfma_f32_16x16x32_bf16 v[88:91], v[144:147], v[104:107], v[88:91]
 ds_read_b128 v[208:211], v58 offset:2112
 v_mfma_f32_16x16x32_bf16 v[92:95], v[144:147], v[108:111], v[92:95]
 v_mfma_f32_16x16x32_bf16 v[84:87], v[148:151], v[96:99], v[84:87]
 ds_read_b128 v[212:215], v58 offset:2624
 v_mfma_f32_16x16x32_bf16 v[88:91], v[148:151], v[100:103], v[88:91]
 ds_read_b128 v[216:219], v58 offset:3136
 v_mfma_f32_16x16x32_bf16 v[92:95], v[148:151], v[104:107], v[92:95]
 s_waitcnt lgkmcnt(15)
 v_mfma_f32_16x16x32_bf16 v[88:91], v[152:155], v[96:99], v[88:91]
 ds_read_b128 v[220:223], v58 offset:3648
 v_mfma_f32_16x16x32_bf16 v[92:95], v[152:155], v[100:103], v[92:95]
 v_mfma_f32_16x16x32_bf16 v[92:95], v[156:159], v[96:99], v[92:95]
 s_waitcnt lgkmcnt(7)
 v_mfma_f32_16x16x32_bf16 v[64:67], v[192:195], v[160:163], v[64:67]
 ds_read_b128 v[128:131], v58 offset:128
 v_mfma_f32_16x16x32_bf16 v[68:71], v[196:199], v[160:163], v[68:71]
 ds_read_b64 v[96:97], v57 offset:3712
 v_mfma_f32_16x16x32_bf16 v[68:71], v[192:195], v[164:167], v[68:71]
 v_mfma_f32_16x16x32_bf16 v[72:75], v[196:199], v[164:167], v[72:75]
 ds_read_b64 v[98:99], v57 offset:3720
 v_mfma_f32_16x16x32_bf16 v[72:75], v[200:203], v[160:163], v[72:75]
 ds_read_b128 v[132:135], v58 offset:640
 v_mfma_f32_16x16x32_bf16 v[72:75], v[192:195], v[168:171], v[72:75]
 v_mfma_f32_16x16x32_bf16 v[76:79], v[200:203], v[164:167], v[76:79]
 ds_read_b64 v[100:101], v57 offset:3200
 v_mfma_f32_16x16x32_bf16 v[76:79], v[196:199], v[168:171], v[76:79]
 ds_read_b64 v[102:103], v57 offset:3208
 v_mfma_f32_16x16x32_bf16 v[80:83], v[200:203], v[168:171], v[80:83]
 s_waitcnt lgkmcnt(10)
 v_mfma_f32_16x16x32_bf16 v[76:79], v[204:207], v[160:163], v[76:79]
 ds_read_b128 v[136:139], v58 offset:1152
 v_mfma_f32_16x16x32_bf16 v[76:79], v[192:195], v[172:175], v[76:79]
 ds_read_b64 v[104:105], v57 offset:2688
 v_mfma_f32_16x16x32_bf16 v[80:83], v[204:207], v[164:167], v[80:83]
 v_mfma_f32_16x16x32_bf16 v[80:83], v[196:199], v[172:175], v[80:83]
 ds_read_b64 v[106:107], v57 offset:2696
 v_mfma_f32_16x16x32_bf16 v[84:87], v[204:207], v[168:171], v[84:87]
 v_mfma_f32_16x16x32_bf16 v[84:87], v[200:203], v[172:175], v[84:87]
 ds_read_b128 v[140:143], v58 offset:1664
 v_mfma_f32_16x16x32_bf16 v[88:91], v[204:207], v[172:175], v[88:91]
 ds_read_b64 v[108:109], v57 offset:2176
 s_waitcnt lgkmcnt(13)
 v_mfma_f32_16x16x32_bf16 v[80:83], v[208:211], v[160:163], v[80:83]
 v_mfma_f32_16x16x32_bf16 v[84:87], v[208:211], v[164:167], v[84:87]
 ds_read_b64 v[110:111], v57 offset:2184
 v_mfma_f32_16x16x32_bf16 v[88:91], v[208:211], v[168:171], v[88:91]
 ds_read_b128 v[144:147], v58 offset:2176
 v_mfma_f32_16x16x32_bf16 v[92:95], v[208:211], v[172:175], v[92:95]
 v_mfma_f32_16x16x32_bf16 v[84:87], v[212:215], v[160:163], v[84:87]
 ds_read_b128 v[148:151], v58 offset:2688
 v_mfma_f32_16x16x32_bf16 v[88:91], v[212:215], v[164:167], v[88:91]
 ds_read_b128 v[152:155], v58 offset:3200
 v_mfma_f32_16x16x32_bf16 v[92:95], v[212:215], v[168:171], v[92:95]
 s_waitcnt lgkmcnt(15)
 v_mfma_f32_16x16x32_bf16 v[88:91], v[216:219], v[160:163], v[88:91]
 ds_read_b128 v[156:159], v58 offset:3712
 v_mfma_f32_16x16x32_bf16 v[92:95], v[216:219], v[164:167], v[92:95]
 v_mfma_f32_16x16x32_bf16 v[92:95], v[220:223], v[160:163], v[92:95]
 v_add_u32 v57, 128, v57
 v_add_u32 v58, 128, v58
 s_add_u32 s17, s17, 1
 s_cmp_lt_u32 s17, 4
 s_cbranch_scc1 LA_convF
 s_waitcnt lgkmcnt(0)
 v_add_u32 v29, s13, v59
 v_cvt_pk_bf16_f32 v64, v64, v65
 v_cvt_pk_bf16_f32 v66, v66, v67
 ds_write_b32 v29, v64 offset:0
 ds_write_b32 v29, v66 offset:64
 v_cvt_pk_bf16_f32 v68, v68, v69
 v_cvt_pk_bf16_f32 v70, v70, v71
 ds_write_b32 v29, v68 offset:512
 ds_write_b32 v29, v70 offset:576
 v_cvt_pk_bf16_f32 v72, v72, v73
 v_cvt_pk_bf16_f32 v74, v74, v75
 ds_write_b32 v29, v72 offset:1024
 ds_write_b32 v29, v74 offset:1088
 v_cvt_pk_bf16_f32 v76, v76, v77
 v_cvt_pk_bf16_f32 v78, v78, v79
 ds_write_b32 v29, v76 offset:1536
 ds_write_b32 v29, v78 offset:1600
 v_add_f32 v80, v80, v224
 v_add_f32 v81, v81, v225
 v_add_f32 v82, v82, v226
 v_add_f32 v83, v83, v227
 v_cvt_pk_bf16_f32 v80, v80, v81
 v_cvt_pk_bf16_f32 v82, v82, v83
 ds_write_b32 v29, v80 offset:2048
 ds_write_b32 v29, v82 offset:2112
 v_add_f32 v84, v84, v228
 v_add_f32 v85, v85, v229
 v_add_f32 v86, v86, v230
 v_add_f32 v87, v87, v231
 v_cvt_pk_bf16_f32 v84, v84, v85
 v_cvt_pk_bf16_f32 v86, v86, v87
 ds_write_b32 v29, v84 offset:2560
 ds_write_b32 v29, v86 offset:2624
 v_add_f32 v88, v88, v232
 v_add_f32 v89, v89, v233
 v_add_f32 v90, v90, v234
 v_add_f32 v91, v91, v235
 v_cvt_pk_bf16_f32 v88, v88, v89
 v_cvt_pk_bf16_f32 v90, v90, v91
 ds_write_b32 v29, v88 offset:3072
 ds_write_b32 v29, v90 offset:3136
 v_add_f32 v92, v92, v236
 v_add_f32 v93, v93, v237
 v_add_f32 v94, v94, v238
 v_add_f32 v95, v95, v239
 v_cvt_pk_bf16_f32 v92, v92, v93
 v_cvt_pk_bf16_f32 v94, v94, v95
 ds_write_b32 v29, v92 offset:3584
 ds_write_b32 v29, v94 offset:3648
 v_add_u32 v57, 70976, v57
 v_add_u32 v58, 70976, v58
 v_mov_b32 v64, 0
 v_mov_b32 v65, 0
 v_mov_b32 v66, 0
 v_mov_b32 v67, 0
 v_mov_b32 v68, 0
 v_mov_b32 v69, 0
 v_mov_b32 v70, 0
 v_mov_b32 v71, 0
 v_mov_b32 v72, 0
 v_mov_b32 v73, 0
 v_mov_b32 v74, 0
 v_mov_b32 v75, 0
 v_mov_b32 v76, 0
 v_mov_b32 v77, 0
 v_mov_b32 v78, 0
 v_mov_b32 v79, 0
LA_s5:
 ds_read_b32 v34, v38 offset:4
 s_waitcnt lgkmcnt(0)
 v_readfirstlane_b32 s11, v34
 s_nop 0
 s_cmp_lt_u32 s11, 4
 s_cbranch_scc1 LA_s5
 s_waitcnt lgkmcnt(0)
 ds_read_b128 v[128:131], v58 offset:0
 ds_read_b64 v[96:97], v57 offset:3584
 ds_read_b64 v[98:99], v57 offset:3592
 ds_read_b128 v[132:135], v58 offset:512
 ds_read_b64 v[100:101], v57 offset:3072
 ds_read_b64 v[102:103], v57 offset:3080
 ds_read_b128 v[136:139], v58 offset:1024
 ds_read_b64 v[104:105], v57 offset:2560
 ds_read_b64 v[106:107], v57 offset:2568
 ds_read_b128 v[140:143], v58 offset:1536
 ds_read_b64 v[108:109], v57 offset:2048
 ds_read_b64 v[110:111], v57 offset:2056
 s_mov_b32 s17, 0
LA_conv1:
 s_waitcnt lgkmcnt(3)
 v_mfma_f32_16x16x32_bf16 v[64:67], v[128:131], v[96:99], v[64:67]
 ds_read_b128 v[192:195], v58 offset:64
 ds_read_b64 v[160:161], v57 offset:3648
 v_mfma_f32_16x16x32_bf16 v[68:71], v[132:135], v[96:99], v[68:71]
 ds_read_b64 v[162:163], v57 offset:3656
 v_mfma_f32_16x16x32_bf16 v[68:71], v[128:131], v[100:103], v[68:71]
 ds_read_b128 v[196:199], v58 offset:576
 v_mfma_f32_16x16x32_bf16 v[72:75], v[132:135], v[100:103], v[72:75]
 ds_read_b64 v[164:165], v57 offset:3136
 ds_read_b64 v[166:167], v57 offset:3144
 v_mfma_f32_16x16x32_bf16 v[72:75], v[136:139], v[96:99], v[72:75]
 ds_read_b128 v[200:203], v58 offset:1088
 v_mfma_f32_16x16x32_bf16 v[72:75], v[128:131], v[104:107], v[72:75]
 ds_read_b64 v[168:169], v57 offset:2624
 v_mfma_f32_16x16x32_bf16 v[76:79], v[136:139], v[100:103], v[76:79]
 ds_read_b64 v[170:171], v57 offset:2632
 ds_read_b128 v[204:207], v58 offset:1600
 v_mfma_f32_16x16x32_bf16 v[76:79], v[132:135], v[104:107], v[76:79]
 ds_read_b64 v[172:173], v57 offset:2112
 s_waitcnt lgkmcnt(11)
 v_mfma_f32_16x16x32_bf16 v[76:79], v[140:143], v[96:99], v[76:79]
 ds_read_b64 v[174:175], v57 offset:2120
 v_mfma_f32_16x16x32_bf16 v[76:79], v[128:131], v[108:111], v[76:79]
 s_waitcnt lgkmcnt(3)
 v_mfma_f32_16x16x32_bf16 v[64:67], v[192:195], v[160:163], v[64:67]
 ds_read_b128 v[128:131], v58 offset:128
 ds_read_b64 v[96:97], v57 offset:3712
 v_mfma_f32_16x16x32_bf16 v[68:71], v[196:199], v[160:163], v[68:71]
 ds_read_b64 v[98:99], v57 offset:3720
 v_mfma_f32_16x16x32_bf16 v[68:71], v[192:195], v[164:167], v[68:71]
 ds_read_b128 v[132:135], v58 offset:640
 v_mfma_f32_16x16x32_bf16 v[72:75], v[196:199], v[164:167], v[72:75]
 ds_read_b64 v[100:101], v57 offset:3200
 ds_read_b64 v[102:103], v57 offset:3208
 v_mfma_f32_16x16x32_bf16 v[72:75], v[200:203], v[160:163], v[72:75]
 ds_read_b128 v[136:139], v58 offset:1152
 v_mfma_f32_16x16x32_bf16 v[72:75], v[192:195], v[168:171], v[72:75]
 ds_read_b64 v[104:105], v57 offset:2688
 v_mfma_f32_16x16x32_bf16 v[76:79], v[200:203], v[164:167], v[76:79]
 ds_read_b64 v[106:107], v57 offset:2696
 ds_read_b128 v[140:143], v58 offset:1664
 v_mfma_f32_16x16x32_bf16 v[76:79], v[196:199], v[168:171], v[76:79]
 ds_read_b64 v[108:109], v57 offset:2176
 s_waitcnt lgkmcnt(11)
 v_mfma_f32_16x16x32_bf16 v[76:79], v[204:207], v[160:163], v[76:79]
 ds_read_b64 v[110:111], v57 offset:2184
 v_mfma_f32_16x16x32_bf16 v[76:79], v[192:195], v[172:175], v[76:79]
 v_add_u32 v57, 128, v57
 v_add_u32 v58, 128, v58
 s_add_u32 s17, s17, 1
 s_cmp_lt_u32 s17, 4
 s_cbranch_scc1 LA_conv1
 s_waitcnt lgkmcnt(0)
 s_mul_i32 s11, s20, 2624
 s_add_u32 s11, s11, 142976
 v_add_u32 v29, s11, v59
 v_cvt_pk_bf16_f32 v64, v64, v65
 v_cvt_pk_bf16_f32 v66, v66, v67
 ds_write_b32 v29, v64 offset:0
 ds_write_b32 v29, v66 offset:64
 v_cvt_pk_bf16_f32 v68, v68, v69
 v_cvt_pk_bf16_f32 v70, v70, v71
 ds_write_b32 v29, v68 offset:512
 ds_write_b32 v29, v70 offset:576
 v_cvt_pk_bf16_f32 v72, v72, v73
 v_cvt_pk_bf16_f32 v74, v74, v75
 ds_write_b32 v29, v72 offset:1024
 ds_write_b32 v29, v74 offset:1088
 v_cvt_pk_bf16_f32 v76, v76, v77
 v_cvt_pk_bf16_f32 v78, v78, v79
 ds_write_b32 v29, v76 offset:1536
 ds_write_b32 v29, v78 offset:1600
 s_waitcnt lgkmcnt(0)
 s_waitcnt lgkmcnt(0)
 s_mov_b64 exec, 1
 ds_add_u32 v38, v39
 s_mov_b64 exec, -1
LA_s3:
 ds_read_b32 v34, v38
 s_waitcnt lgkmcnt(0)
 v_readfirstlane_b32 s11, v34
 s_nop 0
 s_cmp_lt_u32 s11, 16
 s_cbranch_scc1 LA_s3
 ds_read_b64_tr_b16 v[96:97], v60 offset:0
 ds_read_b64_tr_b16 v[98:99], v61 offset:0
 ds_read_b64_tr_b16 v[100:101], v60 offset:512
 ds_read_b64_tr_b16 v[102:103], v61 offset:512
 ds_read_b64_tr_b16 v[104:105], v60 offset:1024
 ds_read_b64_tr_b16 v[106:107], v61 offset:1024
 ds_read_b64_tr_b16 v[108:109], v60 offset:1536
 ds_read_b64_tr_b16 v[110:111], v61 offset:1536
 s_add_u32 s11, s16, 0
 s_waitcnt lgkmcnt(6)
 buffer_store_dwordx4 v[96:99], v62, s[72:75], s11 offen
 s_add_u32 s11, s16, 655360
 s_waitcnt lgkmcnt(4)
 buffer_store_dwordx4 v[100:103], v62, s[72:75], s11 offen
 s_add_u32 s11, s16, 1310720
 s_waitcnt lgkmcnt(2)
 buffer_store_dwordx4 v[104:107], v62, s[72:75], s11 offen
 s_add_u32 s11, s16, 1966080
 s_waitcnt lgkmcnt(0)
 buffer_store_dwordx4 v[108:111], v62, s[72:75], s11 offen
 s_branch LA_last
LA_young:
 v_min_u32 v29, 55, v1
 v_lshlrev_b32 v29, 3, v29
 v_add_u32 v29, s13, v29
 ds_write_b64 v29, v[64:65] offset:8704
 ds_write_b64 v29, v[64:65] offset:13280
 v_mov_b32 v39, 1
 s_waitcnt lgkmcnt(0)
 s_mov_b64 exec, 1
 ds_add_u32 v38, v39 offset:4
 s_mov_b64 exec, -1
LA_s8:
 ds_read_b32 v34, v38 offset:0
 s_waitcnt lgkmcnt(0)
 v_readfirstlane_b32 s11, v34
 s_nop 0
 s_cmp_lt_u32 s11, 4
 s_cbranch_scc1 LA_s8
 ds_read_b128 v[128:131], v16 offset:0
 ds_read_b128 v[132:135], v16 offset:16
 ds_read_b128 v[136:139], v16 offset:512
 ds_read_b128 v[140:143], v16 offset:528
 ds_read_b128 v[144:147], v16 offset:1024
 ds_read_b128 v[148:151], v16 offset:1040
 ds_read_b128 v[152:155], v16 offset:1536
 ds_read_b128 v[156:159], v16 offset:1552
 ds_read_b64 v[240:241], v57 offset:1920
 ds_read_b64 v[242:243], v57 offset:1928
 ds_read_b128 v[192:195], v58 offset:384
 ds_read_b128 v[196:199], v58 offset:896
 ds_read_b128 v[200:203], v58 offset:1408
 ds_read_b128 v[204:207], v58 offset:1920
 s_waitcnt lgkmcnt(12)
 v_mfma_f32_16x16x32_bf16 v[160:163], v[128:131], v[8:11], 0
 ds_read_b64 v[244:245], v57 offset:1984
 ds_read_b64 v[246:247], v57 offset:1992
 v_mfma_f32_16x16x32_bf16 v[164:167], v[132:135], v[12:15], 0
 ds_read_b128 v[208:211], v58 offset:448
 ds_read_b128 v[212:215], v58 offset:960
 s_waitcnt lgkmcnt(14)
 v_mfma_f32_16x16x32_bf16 v[168:171], v[136:139], v[8:11], 0
 ds_read_b128 v[216:219], v58 offset:1472
 ds_read_b128 v[220:223], v58 offset:1984
 v_mfma_f32_16x16x32_bf16 v[172:175], v[140:143], v[12:15], 0
 ds_read_b64 v[96:97], v57 offset:1216
 ds_read_b64 v[98:99], v57 offset:1224
 s_waitcnt lgkmcnt(15)
 v_mfma_f32_16x16x32_bf16 v[176:179], v[144:147], v[8:11], 0
 ds_read_b64 v[100:101], v57 offset:1152
 ds_read_b64 v[102:103], v57 offset:1160
 v_mfma_f32_16x16x32_bf16 v[180:183], v[148:151], v[12:15], 0
 ds_read_b64 v[104:105], v57 offset:1088
 ds_read_b64 v[106:107], v57 offset:1096
 s_waitcnt lgkmcnt(15)
 v_mfma_f32_16x16x32_bf16 v[184:187], v[152:155], v[8:11], 0
 ds_read_b64 v[108:109], v57 offset:1024
 ds_read_b64 v[110:111], v57 offset:1032
 v_mfma_f32_16x16x32_bf16 v[188:191], v[156:159], v[12:15], 0
 s_waitcnt lgkmcnt(8)
 v_mfma_f32_16x16x32_bf16 v[80:83], v[192:195], v[240:243], 0
 v_cvt_pk_bf16_f32 v112, v160, v164
 v_cvt_pk_bf16_f32 v113, v161, v165
 v_mfma_f32_16x16x32_bf16 v[84:87], v[196:199], v[240:243], 0
 v_cvt_pk_bf16_f32 v114, v162, v166
 v_cvt_pk_bf16_f32 v115, v163, v167
 v_mfma_f32_16x16x32_bf16 v[88:91], v[200:203], v[240:243], 0
 v_cvt_pk_bf16_f32 v116, v168, v172
 v_cvt_pk_bf16_f32 v117, v169, v173
 v_mfma_f32_16x16x32_bf16 v[92:95], v[204:207], v[240:243], 0
 v_cvt_pk_bf16_f32 v118, v170, v174
 v_cvt_pk_bf16_f32 v119, v171, v175
 v_mfma_f32_16x16x32_bf16 v[80:83], v[208:211], v[244:247], v[80:83]
 v_cvt_pk_bf16_f32 v120, v176, v180
 v_cvt_pk_bf16_f32 v121, v177, v181
 v_mfma_f32_16x16x32_bf16 v[84:87], v[212:215], v[244:247], v[84:87]
 v_cvt_pk_bf16_f32 v122, v178, v182
 v_cvt_pk_bf16_f32 v123, v179, v183
 v_mfma_f32_16x16x32_bf16 v[88:91], v[216:219], v[244:247], v[88:91]
 v_cvt_pk_bf16_f32 v124, v184, v188
 v_cvt_pk_bf16_f32 v125, v185, v189
 v_mfma_f32_16x16x32_bf16 v[92:95], v[220:223], v[244:247], v[92:95]
 v_cvt_pk_bf16_f32 v126, v186, v190
 v_cvt_pk_bf16_f32 v127, v187, v191
 s_waitcnt lgkmcnt(0)
 v_mfma_f32_16x16x32_bf16 v[128:131], v[112:115], v[96:99], 0
 v_mfma_f32_16x16x32_bf16 v[132:135], v[116:119], v[96:99], 0
 v_mfma_f32_16x16x32_bf16 v[132:135], v[112:115], v[100:103], v[132:135]
 v_mfma_f32_16x16x32_bf16 v[136:139], v[120:123], v[96:99], 0
 v_mfma_f32_16x16x32_bf16 v[136:139], v[116:119], v[100:103], v[136:139]
 v_mfma_f32_16x16x32_bf16 v[136:139], v[112:115], v[104:107], v[136:139]
 v_mfma_f32_16x16x32_bf16 v[140:143], v[124:127], v[96:99], 0
 v_mfma_f32_16x16x32_bf16 v[140:143], v[120:123], v[100:103], v[140:143]
 v_mfma_f32_16x16x32_bf16 v[140:143], v[116:119], v[104:107], v[140:143]
 v_mfma_f32_16x16x32_bf16 v[140:143], v[112:115], v[108:111], v[140:143]
 ds_write_b128 v17, v[128:131] offset:0
 ds_read_b64 v[224:225], v18 offset:0
 ds_read_b64 v[226:227], v18 offset:128
 ds_write_b128 v17, v[132:135] offset:4224
 ds_read_b64 v[228:229], v18 offset:4224
 ds_read_b64 v[230:231], v18 offset:4352
 ds_write_b128 v17, v[136:139] offset:0
 ds_read_b64 v[232:233], v18 offset:0
 ds_read_b64 v[234:235], v18 offset:128
 ds_write_b128 v17, v[140:143] offset:4224
 ds_read_b64 v[236:237], v18 offset:4224
 ds_read_b64 v[238:239], v18 offset:4352
LA_s6:
 ds_read_b32 v34, v38 offset:0
 s_waitcnt lgkmcnt(0)
 v_readfirstlane_b32 s11, v34
 s_nop 0
 s_cmp_lt_u32 s11, 12
 s_cbranch_scc1 LA_s6
LA_c2go:
 s_waitcnt lgkmcnt(0)
 ds_read_b128 v[144:147], v58 offset:2048
 ds_read_b64 v[96:97], v57 offset:3584
 ds_read_b64 v[98:99], v57 offset:3592
 ds_read_b128 v[148:151], v58 offset:2560
 ds_read_b128 v[152:155], v58 offset:3072
 ds_read_b128 v[156:159], v58 offset:3584
 ds_read_b128 v[140:143], v58 offset:1536
 ds_read_b64 v[100:101], v57 offset:3072
 ds_read_b64 v[102:103], v57 offset:3080
 ds_read_b128 v[136:139], v58 offset:1024
 ds_read_b64 v[104:105], v57 offset:2560
 ds_read_b64 v[106:107], v57 offset:2568
 ds_read_b128 v[132:135], v58 offset:512
 ds_read_b64 v[108:109], v57 offset:2048
 ds_read_b64 v[110:111], v57 offset:2056
 s_mov_b32 s17, 0
LA_conv2:
 s_waitcnt lgkmcnt(6)
 v_mfma_f32_16x16x32_bf16 v[80:83], v[144:147], v[96:99], v[80:83]
 ds_read_b128 v[208:211], v58 offset:2112
 v_mfma_f32_16x16x32_bf16 v[84:87], v[148:151], v[96:99], v[84:87]
 ds_read_b64 v[160:161], v57 offset:3648
 v_mfma_f32_16x16x32_bf16 v[88:91], v[152:155], v[96:99], v[88:91]
 ds_read_b64 v[162:163], v57 offset:3656
 v_mfma_f32_16x16x32_bf16 v[92:95], v[156:159], v[96:99], v[92:95]
 ds_read_b128 v[212:215], v58 offset:2624
 v_mfma_f32_16x16x32_bf16 v[80:83], v[140:143], v[100:103], v[80:83]
 ds_read_b128 v[216:219], v58 offset:3136
 v_mfma_f32_16x16x32_bf16 v[84:87], v[144:147], v[100:103], v[84:87]
 ds_read_b128 v[220:223], v58 offset:3648
 v_mfma_f32_16x16x32_bf16 v[88:91], v[148:151], v[100:103], v[88:91]
 ds_read_b128 v[204:207], v58 offset:1600
 v_mfma_f32_16x16x32_bf16 v[92:95], v[152:155], v[100:103], v[92:95]
 ds_read_b64 v[164:165], v57 offset:3136
 s_waitcnt lgkmcnt(8)
 v_mfma_f32_16x16x32_bf16 v[80:83], v[136:139], v[104:107], v[80:83]
 ds_read_b64 v[166:167], v57 offset:3144
 v_mfma_f32_16x16x32_bf16 v[84:87], v[140:143], v[104:107], v[84:87]
 ds_read_b128 v[200:203], v58 offset:1088
 v_mfma_f32_16x16x32_bf16 v[88:91], v[144:147], v[104:107], v[88:91]
 ds_read_b64 v[168:169], v57 offset:2624
 v_mfma_f32_16x16x32_bf16 v[92:95], v[148:151], v[104:107], v[92:95]
 ds_read_b64 v[170:171], v57 offset:2632
 v_mfma_f32_16x16x32_bf16 v[80:83], v[132:135], v[108:111], v[80:83]
 ds_read_b128 v[196:199], v58 offset:576
 v_mfma_f32_16x16x32_bf16 v[84:87], v[136:139], v[108:111], v[84:87]
 ds_read_b64 v[172:173], v57 offset:2112
 v_mfma_f32_16x16x32_bf16 v[88:91], v[140:143], v[108:111], v[88:91]
 ds_read_b64 v[174:175], v57 offset:2120
 v_mfma_f32_16x16x32_bf16 v[92:95], v[144:147], v[108:111], v[92:95]
 s_waitcnt lgkmcnt(6)
 v_mfma_f32_16x16x32_bf16 v[80:83], v[208:211], v[160:163], v[80:83]
 ds_read_b128 v[144:147], v58 offset:2176
 v_mfma_f32_16x16x32_bf16 v[84:87], v[212:215], v[160:163], v[84:87]
 ds_read_b64 v[96:97], v57 offset:3712
 v_mfma_f32_16x16x32_bf16 v[88:91], v[216:219], v[160:163], v[88:91]
 ds_read_b64 v[98:99], v57 offset:3720
 v_mfma_f32_16x16x32_bf16 v[92:95], v[220:223], v[160:163], v[92:95]
 ds_read_b128 v[148:151], v58 offset:2688
 v_mfma_f32_16x16x32_bf16 v[80:83], v[204:207], v[164:167], v[80:83]
 ds_read_b128 v[152:155], v58 offset:3200
 v_mfma_f32_16x16x32_bf16 v[84:87], v[208:211], v[164:167], v[84:87]
 ds_read_b128 v[156:159], v58 offset:3712
 v_mfma_f32_16x16x32_bf16 v[88:91], v[212:215], v[164:167], v[88:91]
 ds_read_b128 v[140:143], v58 offset:1664
 v_mfma_f32_16x16x32_bf16 v[92:95], v[216:219], v[164:167], v[92:95]
 ds_read_b64 v[100:101], v57 offset:3200
 s_waitcnt lgkmcnt(8)
 v_mfma_f32_16x16x32_bf16 v[80:83], v[200:203], v[168:171], v[80:83]
 ds_read_b64 v[102:103], v57 offset:3208
 v_mfma_f32_16x16x32_bf16 v[84:87], v[204:207], v[168:171], v[84:87]
 ds_read_b128 v[136:139], v58 offset:1152
 v_mfma_f32_16x16x32_bf16 v[88:91], v[208:211], v[168:171], v[88:91]
 ds_read_b64 v[104:105], v57 offset:2688
 v_mfma_f32_16x16x32_bf16 v[92:95], v[212:215], v[168:171], v[92:95]
 ds_read_b64 v[106:107], v57 offset:2696
 v_mfma_f32_16x16x32_bf16 v[80:83], v[196:199], v[172:175], v[80:83]
 ds_read_b128 v[132:135], v58 offset:640
 v_mfma_f32_16x16x32_bf16 v[84:87], v[200:203], v[172:175], v[84:87]
 ds_read_b64 v[108:109], v57 offset:2176
 v_mfma_f32_16x16x32_bf16 v[88:91], v[204:207], v[172:175], v[88:91]
 ds_read_b64 v[110:111], v57 offset:2184
 v_mfma_f32_16x16x32_bf16 v[92:95], v[208:211], v[172:175], v[92:95]
 v_add_u32 v57, 128, v57
 v_add_u32 v58, 128, v58
 s_add_u32 s17, s17, 1
 s_cmp_lt_u32 s17, 4
 s_cbranch_scc1 LA_conv2
 s_waitcnt lgkmcnt(0)
LA_s4:
 ds_read_b32 v34, v38
 s_waitcnt lgkmcnt(0)
 v_readfirstlane_b32 s11, v34
 s_nop 0
 s_cmp_lt_u32 s11, 16
 s_cbranch_scc1 LA_s4
 v_add_u32 v29, s13, v59
 v_add_f32 v80, v80, v224
 v_add_f32 v81, v81, v225
 v_add_f32 v82, v82, v226
 v_add_f32 v83, v83, v227
 v_cvt_pk_bf16_f32 v80, v80, v81
 v_cvt_pk_bf16_f32 v82, v82, v83
 ds_write_b32 v29, v80 offset:2048
 ds_write_b32 v29, v82 offset:2112
 v_add_f32 v84, v84, v228
 v_add_f32 v85, v85, v229
 v_add_f32 v86, v86, v230
 v_add_f32 v87, v87, v231
 v_cvt_pk_bf16_f32 v84, v84, v85
 v_cvt_pk_bf16_f32 v86, v86, v87
 ds_write_b32 v29, v84 offset:2560
 ds_write_b32 v29, v86 offset:2624
 v_add_f32 v88, v88, v232
 v_add_f32 v89, v89, v233
 v_add_f32 v90, v90, v234
 v_add_f32 v91, v91, v235
 v_cvt_pk_bf16_f32 v88, v88, v89
 v_cvt_pk_bf16_f32 v90, v90, v91
 ds_write_b32 v29, v88 offset:3072
 ds_write_b32 v29, v90 offset:3136
 v_add_f32 v92, v92, v236
 v_add_f32 v93, v93, v237
 v_add_f32 v94, v94, v238
 v_add_f32 v95, v95, v239
 v_cvt_pk_bf16_f32 v92, v92, v93
 v_cvt_pk_bf16_f32 v94, v94, v95
 ds_write_b32 v29, v92 offset:3584
 ds_write_b32 v29, v94 offset:3648
 s_waitcnt lgkmcnt(0)
LA_last:
 v_add_u32 v61, 71488, v60
 s_barrier
 ds_read_b64_tr_b16 v[128:129], v60 offset:2048
 ds_read_b64_tr_b16 v[130:131], v61 offset:2048
 ds_read_b64_tr_b16 v[132:133], v60 offset:3072
 ds_read_b64_tr_b16 v[134:135], v61 offset:3072
LA_e2r:
 s_waitcnt lgkmcnt(0)
 s_add_u32 s11, s16, 2621440
 buffer_store_dwordx4 v[128:131], v62, s[72:75], s11 offen
 s_add_u32 s11, s16, 3932160
 buffer_store_dwordx4 v[132:135], v62, s[72:75], s11 offen
LA_e2s:
 s_waitcnt vmcnt(0)
L_fin:
L_end:
 s_endpgm
.p2align 6
L_tab:
 .long 4096, 50990144, 169347200, 352781344, 471142496, 0, 4096, 4160
 .long 4112, 50990160, 169347216, 352781360, 471142512, 0, 4112, 4176
 .long 4128, 50990176, 236521472, 352781376, 471142528, 0, 4128, 4192
 .long 4144, 50990192, 236521488, 352781392, 471142544, 0, 4144, 4208
 .long 4160, 50990208, 236521504, 352781408, 420876288, 0, 4160, 4096
 .long 4176, 50990224, 236521520, 352781424, 420876304, 0, 4176, 4112
 .long 4192, 118164480, 236521536, 352781440, 420876320, 0, 4192, 4128
 .long 4208, 118164496, 236521552, 352781456, 420876336, 0, 4208, 4144
 .long 4224, 118164512, 236521568, 302777344, 420876352, 0, 5376, 5440
 .long 4240, 118164528, 236521584, 302777360, 420876368, 0, 5392, 5456
 .long 67178496, 118164544, 236521600, 302777376, 420876384, 0, 5408, 5472
 .long 67178512, 118164560, 236521616, 302777392, 420876400, 0, 5424, 5488
 .long 67178528, 118164576, 186255360, 302777408, 420876416, 0, 5440, 5376
 .long 67178544, 118164592, 186255376, 302777424, 420876432, 0, 5456, 5392
 .long 67178560, 118164608, 186255392, 302777440, 488050688, 0, 5472, 5408
 .long 67178576, 118164624, 186255408, 302777456, 488050704, 0, 5488, 5424
 .long 67178592, 135269376, 186255424, 302777472, 488050720, 0, 6672, 6736
 .long 67178608, 135269392, 186255440, 302777488, 488050736, 0, 6656, 6720
 .long 67178624, 135269408, 186255456, 369951744, 488050752, 0, 6704, 6768
 .long 67178640, 135269424, 186255472, 369951760, 488050768, 0, 6688, 6752
 .long 16912384, 135269440, 186255488, 369951776, 488050784, 0, 6736, 6672
 .long 16912400, 135269456, 186255504, 369951792, 488050800, 0, 6720, 6656
 .long 16912416, 135269472, 253429760, 369951808, 488050816, 0, 6768, 6704
 .long 16912432, 135269488, 253429776, 369951824, 488050832, 0, 6752, 6688
 .long 16912448, 135269504, 253429792, 369951840, 438046720, 0, 7952, 8016
 .long 16912464, 135269520, 253429808, 369951856, 438046736, 0, 7936, 8000
 .long 16912480, 202443776, 253429824, 369951872, 438046752, 0, 7984, 8048
 .long 16912496, 202443792, 253429840, 369951888, 438046768, 0, 7968, 8032
 .long 16912512, 202443808, 253429856, 319685632, 438046784, 0, 8016, 7952
 .long 16912528, 202443824, 253429872, 319685648, 438046800, 0, 8000, 7936
 .long 84086784, 202443840, 253429888, 319685664, 438046816, 0, 8048, 7984
 .long 84086800, 202443856, 253429904, 319685680, 438046832, 0, 8032, 7968
 .long 84086816, 202443872, 268699648, 319685696, 438046848, 0, 9248, 9312
 .long 84086832, 202443888, 268699664, 319685712, 438046864, 0, 9264, 9328
 .long 84086848, 202443904, 268699680, 319685728, 505221120, 0, 9216, 9280
 .long 84086864, 202443920, 268699696, 319685744, 505221136, 0, 9232, 9296
 .long 84086880, 152177664, 268699712, 319685760, 505221152, 0, 9312, 9248
 .long 84086896, 152177680, 268699728, 319685776, 505221168, 0, 9328, 9264
 .long 84086912, 152177696, 268699744, 386860032, 505221184, 0, 9280, 9216
 .long 84086928, 152177712, 268699760, 386860048, 505221200, 0, 9296, 9232
 .long 34082816, 152177728, 268699776, 386860064, 505221216, 0, 10528, 10592
 .long 34082832, 152177744, 268699792, 386860080, 505221232, 0, 10544, 10608
 .long 34082848, 152177760, 335874048, 386860096, 505221248, 0, 10496, 10560
 .long 34082864, 152177776, 335874064, 386860112, 505221264, 0, 10512, 10576
 .long 34082880, 152177792, 335874080, 386860128, 454955008, 0, 10592, 10528
 .long 34082896, 152177808, 335874096, 386860144, 454955024, 0, 10608, 10544
 .long 34082912, 219352064, 335874112, 386860160, 454955040, 0, 10560, 10496
 .long 34082928, 219352080, 335874128, 386860176, 454955056, 0, 10576, 10512
 .long 34082944, 219352096, 335874144, 403964928, 454955072, 0, 11824, 11888
 .long 34082960, 219352112, 335874160, 403964944, 454955088, 0, 11808, 11872
 .long 101257216, 219352128, 335874176, 403964960, 454955104, 0, 11792, 11856
 .long 101257232, 219352144, 335874192, 403964976, 454955120, 0, 11776, 11840
 .long 101257248, 219352160, 285607936, 403964992, 454955136, 0, 11888, 11824
 .long 101257264, 219352176, 285607952, 403965008, 454955152, 0, 11872, 11808
 .long 101257280, 219352192, 285607968, 403965024, 522129408, 0, 11856, 11792
 .long 101257296, 219352208, 285607984, 403965040, 522129424, 0, 11840, 11776
 .long 101257312, 169348096, 285608000, 403965056, 522129440, 0, 13104, 13168
 .long 101257328, 169348112, 285608016, 403965072, 522129456, 0, 13088, 13152
 .long 101257344, 169348128, 285608032, 471139328, 522129472, 0, 13072, 13136
 .long 101257360, 169348144, 285608048, 471139344, 522129488, 0, 13056, 13120
 .long 50991104, 169348160, 285608064, 471139360, 522129504, 0, 13168, 13104
 .long 50991120, 169348176, 285608080, 471139376, 522129520, 0, 13152, 13088
 .long 50991136, 169348192, 352782336, 471139392, 522129536, 0, 13136, 13072
 .long 50991152, 169348208, 352782352, 471139408, 522129552, 0, 13120, 13056
 .long 538972160, 589958208, 708315264, 891749408, 1010110560, 0, 4096, 4160
 .long 538972176, 589958224, 708315280, 891749424, 1010110576, 0, 4112, 4176
 .long 538972192, 589958240, 775489536, 891749440, 1010110592, 0, 4128, 4192
 .long 538972208, 589958256, 775489552, 891749456, 1010110608, 0, 4144, 4208
 .long 538972224, 589958272, 775489568, 891749472, 959844352, 0, 4160, 4096
 .long 538972240, 589958288, 775489584, 891749488, 959844368, 0, 4176, 4112
 .long 538972256, 657132544, 775489600, 891749504, 959844384, 0, 4192, 4128
 .long 538972272, 657132560, 775489616, 891749520, 959844400, 0, 4208, 4144
 .long 538972288, 657132576, 775489632, 841745408, 959844416, 0, 5376, 5440
 .long 538972304, 657132592, 775489648, 841745424, 959844432, 0, 5392, 5456
 .long 606146560, 657132608, 775489664, 841745440, 959844448, 0, 5408, 5472
 .long 606146576, 657132624, 775489680, 841745456, 959844464, 0, 5424, 5488
 .long 606146592, 657132640, 725223424, 841745472, 959844480, 0, 5440, 5376
 .long 606146608, 657132656, 725223440, 841745488, 959844496, 0, 5456, 5392
 .long 606146624, 657132672, 725223456, 841745504, 1027018752, 0, 5472, 5408
 .long 606146640, 657132688, 725223472, 841745520, 1027018768, 0, 5488, 5424
 .long 606146656, 674237440, 725223488, 841745536, 1027018784, 0, 6672, 6736
 .long 606146672, 674237456, 725223504, 841745552, 1027018800, 0, 6656, 6720
 .long 606146688, 674237472, 725223520, 908919808, 1027018816, 0, 6704, 6768
 .long 606146704, 674237488, 725223536, 908919824, 1027018832, 0, 6688, 6752
 .long 555880448, 674237504, 725223552, 908919840, 1027018848, 0, 6736, 6672
 .long 555880464, 674237520, 725223568, 908919856, 1027018864, 0, 6720, 6656
 .long 555880480, 674237536, 792397824, 908919872, 1027018880, 0, 6768, 6704
 .long 555880496, 674237552, 792397840, 908919888, 1027018896, 0, 6752, 6688
 .long 555880512, 674237568, 792397856, 908919904, 977014784, 0, 7952, 8016
 .long 555880528, 674237584, 792397872, 908919920, 977014800, 0, 7936, 8000
 .long 555880544, 741411840, 792397888, 908919936, 977014816, 0, 7984, 8048
 .long 555880560, 741411856, 792397904, 908919952, 977014832, 0, 7968, 8032
 .long 555880576, 741411872, 792397920, 858653696, 977014848, 0, 8016, 7952
 .long 555880592, 741411888, 792397936, 858653712, 977014864, 0, 8000, 7936
 .long 623054848, 741411904, 792397952, 858653728, 977014880, 0, 8048, 7984
 .long 623054864, 741411920, 792397968, 858653744, 977014896, 0, 8032, 7968
 .long 623054880, 741411936, 807667712, 858653760, 977014912, 0, 9248, 9312
 .long 623054896, 741411952, 807667728, 858653776, 977014928, 0, 9264, 9328
 .long 623054912, 741411968, 807667744, 858653792, 1044189184, 0, 9216, 9280
 .long 623054928, 741411984, 807667760, 858653808, 1044189200, 0, 9232, 9296
 .long 623054944, 691145728, 807667776, 858653824, 1044189216, 0, 9312, 9248
 .long 623054960, 691145744, 807667792, 858653840, 1044189232, 0, 9328, 9264
 .long 623054976, 691145760, 807667808, 925828096, 1044189248, 0, 9280, 9216
 .long 623054992, 691145776, 807667824, 925828112, 1044189264, 0, 9296, 9232
 .long 573050880, 691145792, 807667840, 925828128, 1044189280, 0, 10528, 10592
 .long 573050896, 691145808, 807667856, 925828144, 1044189296, 0, 10544, 10608
 .long 573050912, 691145824, 874842112, 925828160, 1044189312, 0, 10496, 10560
 .long 573050928, 691145840, 874842128, 925828176, 1044189328, 0, 10512, 10576
 .long 573050944, 691145856, 874842144, 925828192, 993923072, 0, 10592, 10528
 .long 573050960, 691145872, 874842160, 925828208, 993923088, 0, 10608, 10544
 .long 573050976, 758320128, 874842176, 925828224, 993923104, 0, 10560, 10496
 .long 573050992, 758320144, 874842192, 925828240, 993923120, 0, 10576, 10512
 .long 573051008, 758320160, 874842208, 942932992, 993923136, 0, 11824, 11888
 .long 573051024, 758320176, 874842224, 942933008, 993923152, 0, 11808, 11872
 .long 640225280, 758320192, 874842240, 942933024, 993923168, 0, 11792, 11856
 .long 640225296, 758320208, 874842256, 942933040, 993923184, 0, 11776, 11840
 .long 640225312, 758320224, 824576000, 942933056, 993923200, 0, 11888, 11824
 .long 640225328, 758320240, 824576016, 942933072, 993923216, 0, 11872, 11808
 .long 640225344, 758320256, 824576032, 942933088, 1061097472, 0, 11856, 11792
 .long 640225360, 758320272, 824576048, 942933104, 1061097488, 0, 11840, 11776
 .long 640225376, 708316160, 824576064, 942933120, 1061097504, 0, 13104, 13168
 .long 640225392, 708316176, 824576080, 942933136, 1061097520, 0, 13088, 13152
 .long 640225408, 708316192, 824576096, 1010107392, 1061097536, 0, 13072, 13136
 .long 640225424, 708316208, 824576112, 1010107408, 1061097552, 0, 13056, 13120
 .long 589959168, 708316224, 824576128, 1010107424, 1061097568, 0, 13168, 13104
 .long 589959184, 708316240, 824576144, 1010107440, 1061097584, 0, 13152, 13088
 .long 589959200, 708316256, 891750400, 1010107456, 1061097600, 0, 13136, 13072
 .long 589959216, 708316272, 891750416, 1010107472, 1061097616, 0, 13120, 13056
.section .rodata,"a"
.p2align 6
.amdhsa_kernel concat_heads__ssm_conv_s4d__linear_attn_block__prompt_kernel
  .amdhsa_next_free_vgpr 256
  .amdhsa_next_free_sgpr 102
  .amdhsa_accum_offset 256
  .amdhsa_group_segment_fixed_size 0
  .amdhsa_kernarg_size 104
  .amdhsa_user_sgpr_count 2
  .amdhsa_user_sgpr_kernarg_segment_ptr 1
  .amdhsa_system_sgpr_workgroup_id_x 1
.end_amdhsa_kernel
```
